```python
import torch

def _softmax(x, axis=-1):
    return torch.softmax(x, dim=axis)

def _gelu(x):
    return torch.nn.functional.gelu(x, approximate='tanh')

def _silu(x):
    return torch.nn.functional.silu(x)

def _sigmoid(x):
    return torch.sigmoid(x)

def _layernorm(x, axis=-1, eps=1e-05):
    m = x.mean(dim=axis, keepdim=True)
    v = x.var(dim=axis, keepdim=True, unbiased=False)
    return (x - m) / torch.sqrt(v + eps)

def _scatter_add(tgt, idx, src, axis=0):
    return tgt.clone().index_add_(axis, idx, src)

def _segment_sum(src, seg, n):
    out = torch.zeros((n,) + src.shape[1:], dtype=src.dtype)
    return out.index_add_(0, seg, src)

def _pad(x, pw):
    flat = tuple((v for pair in reversed(pw) for v in pair))
    return torch.nn.functional.pad(x, flat)
kernel_name = 'adaLN_cond__gqa_block_cached__swiglu_ffn__decode'

def setup_inputs():

    _w = lambda a: (lambda t: t.to(torch.bfloat16) if t.is_floating_point() else t)(torch.as_tensor(a))

    def _A_setup():
        B, Sq, D = (1, 1, 512)
        Hq, Hkv, Sk, Dh = (32, 8, 32768, 128)
        assert Hq % Hkv == 0, (Hq, Hkv)
        return {'x': _w((lambda *s: torch.randn(*s, dtype=torch.bfloat16) * 0.1)(B, Sq, D)), 'k_cache': _w((lambda *s: torch.randn(*s, dtype=torch.bfloat16) * 0.8)(B, Hkv, Sk, Dh)), 'v_cache': _w((lambda *s: torch.randn(*s, dtype=torch.bfloat16) * 0.8)(B, Hkv, Sk, Dh)), 'wq': _w((lambda *s: torch.randn(*s, dtype=torch.bfloat16) * 0.8)(D, Hq * Dh) * D ** (-0.5)), 'wo': _w((lambda *s: torch.randn(*s, dtype=torch.bfloat16) * 0.8)(Hq * Dh, D) * (Hq * Dh) ** (-0.5))}
    _A_in = _A_setup()

    def _B_setup():
        B, S, D, F = (1, 1, 512, 1792)
        return {'x': _w((lambda *s: torch.randn(*s, dtype=torch.bfloat16) * 0.1)(B, S, D)), 'w_gate': _w((lambda *s: torch.randn(*s, dtype=torch.bfloat16) * 0.1)(D, F)), 'w_up': _w((lambda *s: torch.randn(*s, dtype=torch.bfloat16) * 0.1)(D, F)), 'w_down': _w((lambda *s: torch.randn(*s, dtype=torch.bfloat16) * 0.1)(F, D))}
    _B_in = _B_setup()
    return {'A_x': _A_in['x'], 'A_k_cache': _A_in['k_cache'], 'A_v_cache': _A_in['v_cache'], 'A_wq': _A_in['wq'], 'A_wo': _A_in['wo'], 'B_x': _B_in['x'], 'B_w_gate': _B_in['w_gate'], 'B_w_up': _B_in['w_up'], 'B_w_down': _B_in['w_down'], 'c': _w((lambda *s: torch.randn(*s, dtype=torch.bfloat16) * 0.4)(1, 512) * 8.0), 'w_mod': _w((lambda *s: torch.randn(*s, dtype=torch.bfloat16) * 0.4)(512, 6 * 512) * 512 ** (-0.5) * 8.0)}

def reference(A_x, A_k_cache, A_v_cache, A_wq, A_wo, B_x, B_w_gate, B_w_up, B_w_down, c, w_mod):

    def _A_ref(x, k_cache, v_cache, wq, wo):
        B, Sq, D = x.shape
        Hq, Dh = (32, 128)
        Hkv = k_cache.shape[1]
        rep = Hq // Hkv
        q = (lambda x, *d: x.permute(*d))((x @ wq).reshape(B, Sq, Hq, Dh), 0, 2, 1, 3)
        k = (lambda x, n, axis: torch.repeat_interleave(x, n, dim=axis))(k_cache, rep, axis=1)
        v = (lambda x, n, axis: torch.repeat_interleave(x, n, dim=axis))(v_cache, rep, axis=1)
        scores = torch.einsum('bhqd,bhkd->bhqk', q, k) * Dh ** (-0.5)
        p = _softmax(scores, axis=-1)
        o = torch.einsum('bhqk,bhkd->bhqd', p, v)
        return (lambda x, *d: x.permute(*d))(o, 0, 2, 1, 3).reshape(B, Sq, Hq * Dh) @ wo

    def _B_ref(x, w_gate, w_up, w_down):
        g = _silu(x @ w_gate)
        u = x @ w_up
        return g * u @ w_down
    x = A_x
    mod = (_silu(c) @ w_mod).reshape(c.shape[0], 6, 1, -1)
    sa, ca, ga, sb, cb, gb = (mod[:, 0].clone(), mod[:, 1].clone(), mod[:, 2].clone(), mod[:, 3].clone(), mod[:, 4].clone(), mod[:, 5].clone())
    h = _layernorm(x, axis=-1) * (1 + ca) + sa
    x = x + ga * _A_ref(h, A_k_cache, A_v_cache, A_wq, A_wo)
    h = _layernorm(x, axis=-1) * (1 + cb) + sb
    x = x + gb * _B_ref(h, B_w_gate, B_w_up, B_w_down)
    return x
```

```asm
; @launch grid=(256,1,1) block=(768,1,1) lds=153088
.amdgcn_target "amdgcn-amd-amdhsa--gfx950"
.text
.globl adaLN_cond__gqa_block_cached__swiglu_ffn__decode_kernel
.p2align 8
.type adaLN_cond__gqa_block_cached__swiglu_ffn__decode_kernel,@function
adaLN_cond__gqa_block_cached__swiglu_ffn__decode_kernel:
  s_cmp_ge_u32 s2, 256
  s_cbranch_scc1 L_abort
  s_load_dwordx16 s[8:23], s[0:1], 0
  s_load_dwordx8 s[24:31], s[0:1], 64
  s_load_dwordx4 s[32:35], s[0:1], 96
  v_lshrrev_b32 v1, 6, v0
  s_nop 0
  v_readfirstlane_b32 s3, v1
  v_and_b32 v0, 63, v0
  s_and_b32 s36, s2, 7
  s_lshr_b32 s37, s2, 3
  s_waitcnt lgkmcnt(0)
  s_mov_b32 s40, s34
  s_and_b32 s41, s35, 0xffff
  s_mov_b32 s42, 8388608
  s_mov_b32 s43, 0x00020000
  s_cmp_ge_u32 s3, 8
  s_cbranch_scc1 L_helper
  s_mov_b32 s48, s10
  s_and_b32 s49, s11, 0xffff
  s_mov_b32 s50, 67108864
  s_mov_b32 s51, 0x00020000
  s_mov_b32 s52, s12
  s_and_b32 s53, s13, 0xffff
  s_mov_b32 s54, 67108864
  s_mov_b32 s55, 0x00020000
  v_bfe_u32 v5, v0, 2, 2
  v_lshlrev_b32 v1, 8, v5
  v_lshrrev_b32 v5, 4, v0
  v_lshl_add_u32 v1, v5, 6, v1
  v_and_b32 v5, 3, v0
  v_lshl_add_u32 v1, v5, 4, v1
  v_lshlrev_b32 v2, 4, v0
  v_mov_b32 v3, 0
  v_mov_b32 v4, 0
  v_mov_b32 v6, 0xffff
  v_mov_b32 v7, 0xffff0000
  v_cmp_eq_u32 vcc, 0, v5
  s_nop 1
  v_cndmask_b32 v3, v3, v6, vcc
  v_cmp_eq_u32 vcc, 1, v5
  s_nop 1
  v_cndmask_b32 v3, v3, v7, vcc
  v_cmp_eq_u32 vcc, 2, v5
  s_nop 1
  v_cndmask_b32 v4, v4, v6, vcc
  v_cmp_eq_u32 vcc, 3, v5
  s_nop 1
  v_cndmask_b32 v4, v4, v7, vcc
  s_mov_b32 s56, 0xaaaaaaaa
  s_mov_b32 s57, 0xaaaaaaaa
  s_mov_b32 s58, 0xcccccccc
  s_mov_b32 s59, 0xcccccccc
  v_add_u32 v6, 147712, v1
  s_mul_i32 s63, s3, 10240
  s_add_u32 s63, s63, 65536
  s_mov_b32 s80, 0
  s_add_u32 s78, s34, 3145728
  s_addc_u32 s79, s35, 0
  s_load_dword s83, s[78:79], 0
  s_cmp_lg_u32 s3, 0
  s_cbranch_scc1 L_noinit_1
  v_mov_b32 v8, 0
  v_mov_b32 v9, 0
  v_mov_b32 v10, 0
  v_mov_b32 v11, 0
  v_lshlrev_b32 v12, 2, v0
  v_add_u32 v12, 153024, v12
  v_mov_b32 v13, 0xff800000
  v_cmp_gt_u32 vcc, 4, v0
  s_nop 1
  v_cndmask_b32 v13, v8, v13, vcc
  s_mov_b64 exec, 0x3ff
  ds_write_b32 v12, v13
  s_mov_b64 exec, -1
  s_waitcnt lgkmcnt(0)
L_noinit_1:
  s_sub_u32 s62, s37, 0
  s_cmp_lt_u32 s62, 8
  s_cbranch_scc0 L_nx_2
  s_mul_i32 s62, s62, 33
  s_add_u32 s62, s62, 0
  s_branch L_att_33_2_0_0_0
L_nx_2:
  s_sub_u32 s62, s37, 8
  s_cmp_lt_u32 s62, 8
  s_cbranch_scc0 L_nx_3
  s_mul_i32 s62, s62, 33
  s_add_u32 s62, s62, 264
  s_branch L_att_33_2_0_0_0
L_nx_3:
  s_sub_u32 s62, s37, 16
  s_cmp_lt_u32 s62, 6
  s_cbranch_scc0 L_nx_4
  s_mul_i32 s62, s62, 33
  s_add_u32 s62, s62, 528
  s_branch L_att_33_2_0_0_0
L_nx_4:
  s_sub_u32 s62, s37, 22
  s_cmp_lt_u32 s62, 7
  s_cbranch_scc0 L_nx_5
  s_mul_i32 s62, s62, 28
  s_add_u32 s62, s62, 726
  s_branch L_att_28_2_0_0_0
L_nx_5:
  s_sub_u32 s62, s37, 29
  s_cmp_lt_u32 s62, 3
  s_cbranch_scc0 L_nx_6
  s_mul_i32 s62, s62, 34
  s_add_u32 s62, s62, 922
  s_branch L_att_34_2_0_0_0
L_nx_6:
  s_branch L_abort
L_att_33_2_0_0_0:
  s_lshl_b32 s60, s36, 23
  s_lshl_b32 s61, s62, 13
  s_add_u32 s60, s60, s61
  s_lshl_b32 s61, s3, 10
  s_add_u32 s60, s60, s61
  s_mov_b32 s61, s60
  s_barrier
  buffer_load_dwordx4 v[40:43], v1, s[48:51], s60 offen nt
  s_add_u32 s60, s60, 8192
  buffer_load_dwordx4 v[44:47], v1, s[48:51], s60 offen nt
  s_add_u32 s60, s60, 8192
  buffer_load_dwordx4 v[48:51], v1, s[48:51], s60 offen nt
  s_add_u32 s60, s60, 8192
  s_waitcnt vmcnt(2)
  buffer_load_dwordx4 v[52:55], v1, s[48:51], s60 offen nt
  s_add_u32 s60, s60, 8192
  s_waitcnt vmcnt(2)
  buffer_load_dwordx4 v[56:59], v1, s[48:51], s60 offen nt
  s_add_u32 s60, s60, 8192
  s_waitcnt vmcnt(2)
  buffer_load_dwordx4 v[60:63], v1, s[48:51], s60 offen nt
  s_add_u32 s60, s60, 8192
  s_waitcnt vmcnt(2)
  buffer_load_dwordx4 v[64:67], v1, s[48:51], s60 offen nt
  s_add_u32 s60, s60, 8192
  s_waitcnt vmcnt(2)
  buffer_load_dwordx4 v[68:71], v1, s[48:51], s60 offen nt
  s_add_u32 s60, s60, 8192
  s_waitcnt vmcnt(2)
  buffer_load_dwordx4 v[72:75], v1, s[48:51], s60 offen nt
  s_add_u32 s60, s60, 8192
  s_waitcnt vmcnt(2)
  buffer_load_dwordx4 v[76:79], v1, s[48:51], s60 offen nt
  s_add_u32 s60, s60, 8192
  s_waitcnt vmcnt(2)
  buffer_load_dwordx4 v[80:83], v1, s[48:51], s60 offen nt
  s_add_u32 s60, s60, 8192
  s_waitcnt vmcnt(2)
  buffer_load_dwordx4 v[84:87], v1, s[48:51], s60 offen nt
  s_add_u32 s60, s60, 8192
  s_waitcnt vmcnt(2)
  buffer_load_dwordx4 v[88:91], v1, s[48:51], s60 offen nt
  s_add_u32 s60, s60, 8192
  s_waitcnt vmcnt(2)
  buffer_load_dwordx4 v[92:95], v1, s[48:51], s60 offen nt
  s_add_u32 s60, s60, 8192
  s_waitcnt vmcnt(2)
  buffer_load_dwordx4 v[96:99], v1, s[48:51], s60 offen nt
  s_add_u32 s60, s60, 8192
  s_waitcnt vmcnt(2)
  buffer_load_dwordx4 v[100:103], v1, s[48:51], s60 offen nt
  s_add_u32 s60, s60, 8192
  s_waitcnt vmcnt(2)
  buffer_load_dwordx4 v[104:107], v1, s[48:51], s60 offen nt
  s_add_u32 s60, s60, 8192
  s_waitcnt vmcnt(2)
  buffer_load_dwordx4 v[108:111], v1, s[48:51], s60 offen nt
  s_add_u32 s60, s60, 8192
  s_waitcnt vmcnt(2)
  buffer_load_dwordx4 v[112:115], v1, s[48:51], s60 offen nt
  s_add_u32 s60, s60, 8192
  s_waitcnt vmcnt(2)
  buffer_load_dwordx4 v[116:119], v1, s[48:51], s60 offen nt
  s_add_u32 s60, s60, 8192
  s_waitcnt vmcnt(2)
  buffer_load_dwordx4 v[120:123], v1, s[48:51], s60 offen nt
  s_add_u32 s60, s60, 8192
  s_waitcnt vmcnt(2)
  buffer_load_dwordx4 v[124:127], v1, s[48:51], s60 offen nt
  s_add_u32 s60, s60, 8192
  s_waitcnt vmcnt(2)
  buffer_load_dwordx4 v[128:131], v1, s[48:51], s60 offen nt
  s_add_u32 s60, s60, 8192
  s_waitcnt vmcnt(2)
  buffer_load_dwordx4 v[132:135], v1, s[48:51], s60 offen nt
  s_add_u32 s60, s60, 8192
  s_waitcnt vmcnt(2)
  buffer_load_dwordx4 v[136:139], v1, s[48:51], s60 offen nt
  s_add_u32 s60, s60, 8192
  s_waitcnt vmcnt(2)
  buffer_load_dwordx4 v[140:143], v1, s[48:51], s60 offen nt
  s_add_u32 s60, s60, 8192
  s_waitcnt vmcnt(2)
  buffer_load_dwordx4 v[144:147], v1, s[48:51], s60 offen nt
  s_add_u32 s60, s60, 8192
  s_waitcnt vmcnt(2)
  buffer_load_dwordx4 v[148:151], v1, s[48:51], s60 offen nt
  s_add_u32 s60, s60, 8192
  s_waitcnt vmcnt(2)
  buffer_load_dwordx4 v[152:155], v1, s[48:51], s60 offen nt
  s_add_u32 s60, s60, 8192
  s_waitcnt vmcnt(2)
  buffer_load_dwordx4 v[156:159], v1, s[48:51], s60 offen nt
  s_add_u32 s60, s60, 8192
  s_waitcnt vmcnt(2)
  buffer_load_dwordx4 v[160:163], v1, s[48:51], s60 offen nt
  s_add_u32 s60, s60, 8192
  s_waitcnt vmcnt(2)
  buffer_load_dwordx4 v[164:167], v1, s[48:51], s60 offen nt
  s_add_u32 s60, s60, 8192
  s_waitcnt vmcnt(2)
  s_add_u32 m0, s63, 0
  s_nop 0
  buffer_load_dwordx4 v1, s[48:51], s60 offen nt lds
  s_waitcnt vmcnt(2)
  s_add_u32 m0, s63, 1024
  s_nop 0
  buffer_load_dwordx4 v2, s[52:55], s61 offen nt lds
  s_add_u32 s61, s61, 8192
  s_waitcnt vmcnt(2)
  s_add_u32 m0, s63, 2048
  s_nop 0
  buffer_load_dwordx4 v2, s[52:55], s61 offen nt lds
  s_add_u32 s61, s61, 8192
  s_waitcnt vmcnt(2)
  s_add_u32 m0, s63, 3072
  s_nop 0
  buffer_load_dwordx4 v2, s[52:55], s61 offen nt lds
  s_add_u32 s61, s61, 8192
  s_waitcnt vmcnt(2)
  s_add_u32 m0, s63, 4096
  s_nop 0
  buffer_load_dwordx4 v2, s[52:55], s61 offen nt lds
  s_add_u32 s61, s61, 8192
  s_waitcnt vmcnt(2)
  s_add_u32 m0, s63, 5120
  s_nop 0
  buffer_load_dwordx4 v2, s[52:55], s61 offen nt lds
  s_add_u32 s61, s61, 8192
  s_waitcnt vmcnt(2)
  s_add_u32 m0, s63, 6144
  s_nop 0
  buffer_load_dwordx4 v2, s[52:55], s61 offen nt lds
  s_add_u32 s61, s61, 8192
  s_waitcnt vmcnt(2)
  s_add_u32 m0, s63, 7168
  s_nop 0
  buffer_load_dwordx4 v2, s[52:55], s61 offen nt lds
  s_add_u32 s61, s61, 8192
  s_waitcnt vmcnt(2)
  s_add_u32 m0, s63, 8192
  s_nop 0
  buffer_load_dwordx4 v2, s[52:55], s61 offen nt lds
  s_add_u32 s61, s61, 8192
  s_waitcnt vmcnt(2)
  s_add_u32 m0, s63, 9216
  s_nop 0
  buffer_load_dwordx4 v2, s[52:55], s61 offen nt lds
  s_add_u32 s61, s61, 8192
  s_waitcnt vmcnt(2)
  s_barrier
  ds_read_b128 v[8:11], v6
  v_mov_b32 v12, 153064
  ds_read_b32 v13, v12
  v_add_u32 v6, s63, v2
  s_waitcnt lgkmcnt(0)
  v_readfirstlane_b32 s75, v13
  v_mfma_f32_16x16x32_bf16 v[12:15], v[40:43], v[8:11], 0
  v_mfma_f32_16x16x32_bf16 v[16:19], v[44:47], v[8:11], 0
  v_mfma_f32_16x16x32_bf16 v[20:23], v[48:51], v[8:11], 0
  v_mfma_f32_16x16x32_bf16 v[24:27], v[52:55], v[8:11], 0
  buffer_load_dwordx4 v[40:43], v2, s[52:55], s61 offen nt
  s_add_u32 s61, s61, 8192
  buffer_load_dwordx4 v[44:47], v2, s[52:55], s61 offen nt
  s_add_u32 s61, s61, 8192
  buffer_load_dwordx4 v[48:51], v2, s[52:55], s61 offen nt
  s_add_u32 s61, s61, 8192
  v_cndmask_b32 v36, v12, v17, s[56:57]
  s_nop 0
  v_cndmask_b32 v37, v22, v27, s[56:57]
  v_cndmask_b32 v28, v36, v37, s[58:59]
  v_cndmask_b32 v36, v16, v13, s[56:57]
  v_cndmask_b32 v37, v26, v23, s[56:57]
  v_cndmask_b32 v39, v36, v37, s[58:59]
  s_nop 1
  v_add_f32_dpp v28, v39, v28 quad_perm:[1,0,3,2] row_mask:0xf bank_mask:0xf
  v_cndmask_b32 v36, v20, v25, s[56:57]
  v_cndmask_b32 v37, v14, v19, s[56:57]
  v_cndmask_b32 v38, v36, v37, s[58:59]
  s_nop 1
  v_add_f32_dpp v28, v38, v28 quad_perm:[2,3,0,1] row_mask:0xf bank_mask:0xf
  v_cndmask_b32 v36, v24, v21, s[56:57]
  v_cndmask_b32 v37, v18, v15, s[56:57]
  v_cndmask_b32 v39, v36, v37, s[58:59]
  s_nop 1
  v_add_f32_dpp v28, v39, v28 quad_perm:[3,2,1,0] row_mask:0xf bank_mask:0xf
  v_mfma_f32_16x16x32_bf16 v[12:15], v[56:59], v[8:11], 0
  v_mfma_f32_16x16x32_bf16 v[16:19], v[60:63], v[8:11], 0
  v_mfma_f32_16x16x32_bf16 v[20:23], v[64:67], v[8:11], 0
  v_mfma_f32_16x16x32_bf16 v[24:27], v[68:71], v[8:11], 0
  s_nop 5
  v_cndmask_b32 v36, v12, v17, s[56:57]
  s_nop 0
  v_cndmask_b32 v37, v22, v27, s[56:57]
  v_cndmask_b32 v29, v36, v37, s[58:59]
  v_cndmask_b32 v36, v16, v13, s[56:57]
  v_cndmask_b32 v37, v26, v23, s[56:57]
  v_cndmask_b32 v39, v36, v37, s[58:59]
  s_nop 1
  v_add_f32_dpp v29, v39, v29 quad_perm:[1,0,3,2] row_mask:0xf bank_mask:0xf
  v_cndmask_b32 v36, v20, v25, s[56:57]
  v_cndmask_b32 v37, v14, v19, s[56:57]
  v_cndmask_b32 v38, v36, v37, s[58:59]
  s_nop 1
  v_add_f32_dpp v29, v38, v29 quad_perm:[2,3,0,1] row_mask:0xf bank_mask:0xf
  v_cndmask_b32 v36, v24, v21, s[56:57]
  v_cndmask_b32 v37, v18, v15, s[56:57]
  v_cndmask_b32 v39, v36, v37, s[58:59]
  s_nop 1
  v_add_f32_dpp v29, v39, v29 quad_perm:[3,2,1,0] row_mask:0xf bank_mask:0xf
  v_mfma_f32_16x16x32_bf16 v[12:15], v[72:75], v[8:11], 0
  v_mfma_f32_16x16x32_bf16 v[16:19], v[76:79], v[8:11], 0
  v_mfma_f32_16x16x32_bf16 v[20:23], v[80:83], v[8:11], 0
  v_mfma_f32_16x16x32_bf16 v[24:27], v[84:87], v[8:11], 0
  s_nop 5
  v_cndmask_b32 v36, v12, v17, s[56:57]
  s_nop 0
  v_cndmask_b32 v37, v22, v27, s[56:57]
  v_cndmask_b32 v30, v36, v37, s[58:59]
  v_cndmask_b32 v36, v16, v13, s[56:57]
  v_cndmask_b32 v37, v26, v23, s[56:57]
  v_cndmask_b32 v39, v36, v37, s[58:59]
  s_nop 1
  v_add_f32_dpp v30, v39, v30 quad_perm:[1,0,3,2] row_mask:0xf bank_mask:0xf
  v_cndmask_b32 v36, v20, v25, s[56:57]
  v_cndmask_b32 v37, v14, v19, s[56:57]
  v_cndmask_b32 v38, v36, v37, s[58:59]
  s_nop 1
  v_add_f32_dpp v30, v38, v30 quad_perm:[2,3,0,1] row_mask:0xf bank_mask:0xf
  v_cndmask_b32 v36, v24, v21, s[56:57]
  v_cndmask_b32 v37, v18, v15, s[56:57]
  v_cndmask_b32 v39, v36, v37, s[58:59]
  s_nop 1
  v_add_f32_dpp v30, v39, v30 quad_perm:[3,2,1,0] row_mask:0xf bank_mask:0xf
  v_mfma_f32_16x16x32_bf16 v[12:15], v[88:91], v[8:11], 0
  v_mfma_f32_16x16x32_bf16 v[16:19], v[92:95], v[8:11], 0
  v_mfma_f32_16x16x32_bf16 v[20:23], v[96:99], v[8:11], 0
  v_mfma_f32_16x16x32_bf16 v[24:27], v[100:103], v[8:11], 0
  s_nop 5
  v_cndmask_b32 v36, v12, v17, s[56:57]
  s_nop 0
  v_cndmask_b32 v37, v22, v27, s[56:57]
  v_cndmask_b32 v31, v36, v37, s[58:59]
  v_cndmask_b32 v36, v16, v13, s[56:57]
  v_cndmask_b32 v37, v26, v23, s[56:57]
  v_cndmask_b32 v39, v36, v37, s[58:59]
  s_nop 1
  v_add_f32_dpp v31, v39, v31 quad_perm:[1,0,3,2] row_mask:0xf bank_mask:0xf
  v_cndmask_b32 v36, v20, v25, s[56:57]
  v_cndmask_b32 v37, v14, v19, s[56:57]
  v_cndmask_b32 v38, v36, v37, s[58:59]
  s_nop 1
  v_add_f32_dpp v31, v38, v31 quad_perm:[2,3,0,1] row_mask:0xf bank_mask:0xf
  v_cndmask_b32 v36, v24, v21, s[56:57]
  v_cndmask_b32 v37, v18, v15, s[56:57]
  v_cndmask_b32 v39, v36, v37, s[58:59]
  s_nop 1
  v_add_f32_dpp v31, v39, v31 quad_perm:[3,2,1,0] row_mask:0xf bank_mask:0xf
  v_mfma_f32_16x16x32_bf16 v[12:15], v[104:107], v[8:11], 0
  v_mfma_f32_16x16x32_bf16 v[16:19], v[108:111], v[8:11], 0
  v_mfma_f32_16x16x32_bf16 v[20:23], v[112:115], v[8:11], 0
  v_mfma_f32_16x16x32_bf16 v[24:27], v[116:119], v[8:11], 0
  buffer_load_dwordx4 v[52:55], v2, s[52:55], s61 offen nt
  s_add_u32 s61, s61, 8192
  s_nop 3
  v_cndmask_b32 v36, v12, v17, s[56:57]
  s_nop 0
  v_cndmask_b32 v37, v22, v27, s[56:57]
  v_cndmask_b32 v32, v36, v37, s[58:59]
  v_cndmask_b32 v36, v16, v13, s[56:57]
  v_cndmask_b32 v37, v26, v23, s[56:57]
  v_cndmask_b32 v39, v36, v37, s[58:59]
  s_nop 1
  v_add_f32_dpp v32, v39, v32 quad_perm:[1,0,3,2] row_mask:0xf bank_mask:0xf
  v_cndmask_b32 v36, v20, v25, s[56:57]
  v_cndmask_b32 v37, v14, v19, s[56:57]
  v_cndmask_b32 v38, v36, v37, s[58:59]
  s_nop 1
  v_add_f32_dpp v32, v38, v32 quad_perm:[2,3,0,1] row_mask:0xf bank_mask:0xf
  v_cndmask_b32 v36, v24, v21, s[56:57]
  v_cndmask_b32 v37, v18, v15, s[56:57]
  v_cndmask_b32 v39, v36, v37, s[58:59]
  s_nop 1
  v_add_f32_dpp v32, v39, v32 quad_perm:[3,2,1,0] row_mask:0xf bank_mask:0xf
  v_mfma_f32_16x16x32_bf16 v[12:15], v[120:123], v[8:11], 0
  v_mfma_f32_16x16x32_bf16 v[16:19], v[124:127], v[8:11], 0
  v_mfma_f32_16x16x32_bf16 v[20:23], v[128:131], v[8:11], 0
  v_mfma_f32_16x16x32_bf16 v[24:27], v[132:135], v[8:11], 0
  s_nop 5
  v_cndmask_b32 v36, v12, v17, s[56:57]
  s_nop 0
  v_cndmask_b32 v37, v22, v27, s[56:57]
  v_cndmask_b32 v33, v36, v37, s[58:59]
  v_cndmask_b32 v36, v16, v13, s[56:57]
  v_cndmask_b32 v37, v26, v23, s[56:57]
  v_cndmask_b32 v39, v36, v37, s[58:59]
  s_nop 1
  v_add_f32_dpp v33, v39, v33 quad_perm:[1,0,3,2] row_mask:0xf bank_mask:0xf
  v_cndmask_b32 v36, v20, v25, s[56:57]
  v_cndmask_b32 v37, v14, v19, s[56:57]
  v_cndmask_b32 v38, v36, v37, s[58:59]
  s_nop 1
  v_add_f32_dpp v33, v38, v33 quad_perm:[2,3,0,1] row_mask:0xf bank_mask:0xf
  v_cndmask_b32 v36, v24, v21, s[56:57]
  v_cndmask_b32 v37, v18, v15, s[56:57]
  v_cndmask_b32 v39, v36, v37, s[58:59]
  s_nop 1
  v_add_f32_dpp v33, v39, v33 quad_perm:[3,2,1,0] row_mask:0xf bank_mask:0xf
  v_mfma_f32_16x16x32_bf16 v[12:15], v[136:139], v[8:11], 0
  v_mfma_f32_16x16x32_bf16 v[16:19], v[140:143], v[8:11], 0
  v_mfma_f32_16x16x32_bf16 v[20:23], v[144:147], v[8:11], 0
  v_mfma_f32_16x16x32_bf16 v[24:27], v[148:151], v[8:11], 0
  s_nop 5
  v_cndmask_b32 v36, v12, v17, s[56:57]
  s_nop 0
  v_cndmask_b32 v37, v22, v27, s[56:57]
  v_cndmask_b32 v34, v36, v37, s[58:59]
  v_cndmask_b32 v36, v16, v13, s[56:57]
  v_cndmask_b32 v37, v26, v23, s[56:57]
  v_cndmask_b32 v39, v36, v37, s[58:59]
  s_nop 1
  v_add_f32_dpp v34, v39, v34 quad_perm:[1,0,3,2] row_mask:0xf bank_mask:0xf
  v_cndmask_b32 v36, v20, v25, s[56:57]
  v_cndmask_b32 v37, v14, v19, s[56:57]
  v_cndmask_b32 v38, v36, v37, s[58:59]
  s_nop 1
  v_add_f32_dpp v34, v38, v34 quad_perm:[2,3,0,1] row_mask:0xf bank_mask:0xf
  v_cndmask_b32 v36, v24, v21, s[56:57]
  v_cndmask_b32 v37, v18, v15, s[56:57]
  v_cndmask_b32 v39, v36, v37, s[58:59]
  s_nop 1
  v_add_f32_dpp v34, v39, v34 quad_perm:[3,2,1,0] row_mask:0xf bank_mask:0xf
  v_mfma_f32_16x16x32_bf16 v[12:15], v[152:155], v[8:11], 0
  v_mfma_f32_16x16x32_bf16 v[16:19], v[156:159], v[8:11], 0
  v_mfma_f32_16x16x32_bf16 v[20:23], v[160:163], v[8:11], 0
  v_mfma_f32_16x16x32_bf16 v[24:27], v[164:167], v[8:11], 0
  s_nop 5
  v_cndmask_b32 v36, v12, v17, s[56:57]
  s_nop 0
  v_cndmask_b32 v37, v22, v27, s[56:57]
  v_cndmask_b32 v35, v36, v37, s[58:59]
  v_cndmask_b32 v36, v16, v13, s[56:57]
  v_cndmask_b32 v37, v26, v23, s[56:57]
  v_cndmask_b32 v39, v36, v37, s[58:59]
  s_nop 1
  v_add_f32_dpp v35, v39, v35 quad_perm:[1,0,3,2] row_mask:0xf bank_mask:0xf
  v_cndmask_b32 v36, v20, v25, s[56:57]
  v_cndmask_b32 v37, v14, v19, s[56:57]
  v_cndmask_b32 v38, v36, v37, s[58:59]
  s_nop 1
  v_add_f32_dpp v35, v38, v35 quad_perm:[2,3,0,1] row_mask:0xf bank_mask:0xf
  v_cndmask_b32 v36, v24, v21, s[56:57]
  v_cndmask_b32 v37, v18, v15, s[56:57]
  v_cndmask_b32 v39, v36, v37, s[58:59]
  s_nop 1
  v_add_f32_dpp v35, v39, v35 quad_perm:[3,2,1,0] row_mask:0xf bank_mask:0xf
  ds_read_b128 v[152:155], v6 offset:0
  s_waitcnt lgkmcnt(0)
  v_mfma_f32_16x16x32_bf16 v[12:15], v[152:155], v[8:11], 0
  s_nop 7
  v_cndmask_b32 v36, v12, v17, s[56:57]
  v_cndmask_b32 v37, v22, v27, s[56:57]
  v_cndmask_b32 v7, v36, v37, s[58:59]
  v_cndmask_b32 v36, v16, v13, s[56:57]
  v_cndmask_b32 v37, v26, v23, s[56:57]
  v_cndmask_b32 v39, v36, v37, s[58:59]
  s_nop 1
  v_add_f32_dpp v7, v39, v7 quad_perm:[1,0,3,2] row_mask:0xf bank_mask:0xf
  v_cndmask_b32 v36, v20, v25, s[56:57]
  v_cndmask_b32 v37, v14, v19, s[56:57]
  v_cndmask_b32 v38, v36, v37, s[58:59]
  s_nop 1
  v_add_f32_dpp v7, v38, v7 quad_perm:[2,3,0,1] row_mask:0xf bank_mask:0xf
  v_cndmask_b32 v36, v24, v21, s[56:57]
  v_cndmask_b32 v37, v18, v15, s[56:57]
  v_cndmask_b32 v39, v36, v37, s[58:59]
  s_nop 1
  v_add_f32_dpp v7, v39, v7 quad_perm:[3,2,1,0] row_mask:0xf bank_mask:0xf
  s_mov_b32 s64, 0xeeeeeeee
  s_mov_b32 s65, 0xeeeeeeee
  v_mov_b32 v36, 0xfe000000
  v_cndmask_b32 v7, v7, v36, s[64:65]
  v_cvt_pk_bf16_f32 v36, v28, v29
  v_lshlrev_b32 v28, 16, v36
  v_and_b32 v29, 0xffff0000, v36
  v_cvt_pk_bf16_f32 v37, v30, v31
  v_lshlrev_b32 v30, 16, v37
  v_and_b32 v31, 0xffff0000, v37
  v_cvt_pk_bf16_f32 v36, v32, v33
  v_lshlrev_b32 v32, 16, v36
  v_and_b32 v33, 0xffff0000, v36
  v_cvt_pk_bf16_f32 v37, v34, v35
  v_lshlrev_b32 v34, 16, v37
  v_and_b32 v35, 0xffff0000, v37
  v_cvt_pk_bf16_f32 v36, v7, v7
  v_lshlrev_b32 v7, 16, v36
  s_mov_b32 s62, 0x3db504f3
  v_mul_f32 v28, s62, v28
  v_mul_f32 v29, s62, v29
  v_mul_f32 v30, s62, v30
  v_mul_f32 v31, s62, v31
  v_mul_f32 v32, s62, v32
  v_mul_f32 v33, s62, v33
  v_mul_f32 v34, s62, v34
  v_mul_f32 v35, s62, v35
  v_mul_f32 v7, s62, v7
  v_cvt_pk_bf16_f32 v36, v28, v29
  v_lshlrev_b32 v28, 16, v36
  v_and_b32 v29, 0xffff0000, v36
  v_cvt_pk_bf16_f32 v37, v30, v31
  v_lshlrev_b32 v30, 16, v37
  v_and_b32 v31, 0xffff0000, v37
  v_cvt_pk_bf16_f32 v36, v32, v33
  v_lshlrev_b32 v32, 16, v36
  v_and_b32 v33, 0xffff0000, v36
  v_cvt_pk_bf16_f32 v37, v34, v35
  v_lshlrev_b32 v34, 16, v37
  v_and_b32 v35, 0xffff0000, v37
  v_cvt_pk_bf16_f32 v36, v7, v7
  v_lshlrev_b32 v7, 16, v36
  v_max_f32 v8, v28, v29
  v_max3_f32 v8, v8, v30, v31
  v_max3_f32 v8, v8, v32, v33
  v_max3_f32 v8, v8, v34, v35
  v_max_f32 v8, v8, v7
  s_nop 1
  v_max_f32_dpp v8, v8, v8 quad_perm:[1,0,3,2] row_mask:0xf bank_mask:0xf
  s_nop 1
  v_max_f32_dpp v8, v8, v8 quad_perm:[2,3,0,1] row_mask:0xf bank_mask:0xf
  v_mov_b32 v36, v8
  s_nop 1
  v_permlane16_swap_b32 v8, v36
  v_max_f32 v8, v8, v36
  v_mov_b32 v36, v8
  s_nop 1
  v_permlane32_swap_b32 v8, v36
  v_max_f32 v8, v8, v36
  s_mov_b32 s62, 0x3fb8aa3b
  v_mul_f32 v8, s62, v8
  v_fma_f32 v28, v28, s62, -v8
  v_fma_f32 v29, v29, s62, -v8
  v_fma_f32 v30, v30, s62, -v8
  v_fma_f32 v31, v31, s62, -v8
  v_fma_f32 v32, v32, s62, -v8
  v_fma_f32 v33, v33, s62, -v8
  v_fma_f32 v34, v34, s62, -v8
  v_fma_f32 v35, v35, s62, -v8
  v_fma_f32 v7, v7, s62, -v8
  v_exp_f32 v28, v28
  v_exp_f32 v29, v29
  v_exp_f32 v30, v30
  v_exp_f32 v31, v31
  v_exp_f32 v32, v32
  v_exp_f32 v33, v33
  v_exp_f32 v34, v34
  v_exp_f32 v35, v35
  v_exp_f32 v7, v7
  v_add_f32 v9, v28, v29
  v_add_f32 v9, v9, v30
  v_add_f32 v9, v9, v31
  v_add_f32 v9, v9, v32
  v_add_f32 v9, v9, v33
  v_add_f32 v9, v9, v34
  v_add_f32 v9, v9, v35
  v_add_f32 v9, v9, v7
  v_cvt_pk_bf16_f32 v28, v28, v28
  v_cvt_pk_bf16_f32 v29, v29, v29
  v_cvt_pk_bf16_f32 v30, v30, v30
  v_cvt_pk_bf16_f32 v31, v31, v31
  v_cvt_pk_bf16_f32 v32, v32, v32
  v_cvt_pk_bf16_f32 v33, v33, v33
  v_cvt_pk_bf16_f32 v34, v34, v34
  v_cvt_pk_bf16_f32 v35, v35, v35
  v_cvt_pk_bf16_f32 v7, v7, v7
  v_add_f32_dpp v9, v9, v9 quad_perm:[1,0,3,2] row_mask:0xf bank_mask:0xf
  s_nop 1
  v_add_f32_dpp v9, v9, v9 quad_perm:[2,3,0,1] row_mask:0xf bank_mask:0xf
  v_mov_b32 v36, v9
  s_nop 1
  v_permlane16_swap_b32 v9, v36
  v_add_f32 v9, v9, v36
  v_mov_b32 v36, v9
  s_nop 1
  v_permlane32_swap_b32 v9, v36
  v_add_f32 v9, v9, v36
  v_lshlrev_b32 v152, 5, v0
  v_add_u32 v152, s63, v152
  v_bfe_u32 v165, v0, 2, 2
  s_lshl_b32 s62, s3, 2
  s_add_u32 s62, s62, 147456
  v_lshlrev_b32 v153, 5, v165
  v_add_u32 v153, s62, v153
  v_lshlrev_b32 v154, 2, v165
  v_add_u32 v154, 153024, v154
  v_lshrrev_b32 v165, 4, v0
  v_lshlrev_b32 v155, 5, v165
  v_add_u32 v155, s62, v155
  v_lshlrev_b32 v156, 2, v165
  v_add_u32 v156, 153024, v156
  v_and_b32 v166, 0x33, v0
  v_cmp_eq_u32 s[68:69], 0, v166
  v_mov_b32 v162, 153056
  v_mov_b32 v163, 1
  s_mov_b64 exec, s[68:69]
  ds_write_b32 v153, v8
  ds_max_f32 v154, v8
  s_mov_b64 exec, 1
  ds_add_u32 v162, v163
  s_mov_b64 exec, -1
  v_and_b32 v166, 15, v0
  v_lshrrev_b32 v157, 2, v166
  v_lshlrev_b32 v157, 12, v157
  v_and_b32 v167, 3, v166
  v_lshl_add_u32 v157, v167, 5, v157
  v_and_b32 v164, 1, v165
  v_lshl_add_u32 v157, v164, 4, v157
  v_and_b32 v158, 1, v166
  v_lshlrev_b32 v158, 4, v158
  v_lshl_add_u32 v158, v164, 3, v158
  v_lshrrev_b32 v159, 2, v166
  v_lshl_add_u32 v158, v159, 6, v158
  v_lshrrev_b32 v159, 1, v167
  v_lshl_add_u32 v158, v159, 5, v158
  v_lshrrev_b32 v159, 5, v0
  s_mov_b32 s62, 40960
  v_mul_lo_u32 v159, v159, s62
  v_add_u32 v158, v158, v159
  s_lshr_b32 s62, s3, 1
  s_lshl_b32 s62, s62, 9
  s_and_b32 s64, s3, 1
  s_lshl_b32 s64, s64, 8
  s_add_u32 s62, s62, s64
  s_add_u32 s62, s62, 65536
  v_add_u32 v158, s62, v158
  s_lshr_b32 s62, s3, 1
  s_lshl_b32 s62, s62, 2
  s_add_u32 s62, s62, 153024
  v_mov_b32 v159, s62
  s_lshl_b32 s66, s36, 5
  s_lshl_b32 s62, s3, 2
  s_add_u32 s66, s66, s62
  s_lshl_b32 s66, s66, 5
  s_add_u32 s66, s66, s37
  s_lshl_b32 s66, s66, 7
  s_add_u32 s67, s66, 5242880
  v_add_u32 v10, s63, v2
  s_waitcnt vmcnt(5)
  s_waitcnt vmcnt(4)
  ds_read_b128 v[24:27], v10 offset:1024
  v_and_b32_dpp v20, v28, v3 quad_perm:[0,0,0,0] row_mask:0xf bank_mask:0xf
  v_and_b32_dpp v21, v28, v4 quad_perm:[0,0,0,0] row_mask:0xf bank_mask:0xf
  ds_read_b128 v[36:39], v10 offset:2048
  s_waitcnt lgkmcnt(1)
  v_mfma_f32_16x16x16_bf16 v[12:15], v[20:21], v[24:25], 0
  v_mfma_f32_16x16x16_bf16 v[16:19], v[20:21], v[26:27], 0
  v_and_b32_dpp v22, v28, v3 quad_perm:[1,1,1,1] row_mask:0xf bank_mask:0xf
  v_and_b32_dpp v23, v28, v4 quad_perm:[1,1,1,1] row_mask:0xf bank_mask:0xf
  ds_read_b128 v[24:27], v10 offset:3072
  s_waitcnt lgkmcnt(1)
  v_mfma_f32_16x16x16_bf16 v[12:15], v[22:23], v[36:37], v[12:15]
  v_mfma_f32_16x16x16_bf16 v[16:19], v[22:23], v[38:39], v[16:19]
  v_and_b32_dpp v20, v28, v3 quad_perm:[2,2,2,2] row_mask:0xf bank_mask:0xf
  v_and_b32_dpp v21, v28, v4 quad_perm:[2,2,2,2] row_mask:0xf bank_mask:0xf
  ds_read_b128 v[36:39], v10 offset:4096
  s_waitcnt lgkmcnt(1)
  v_mfma_f32_16x16x16_bf16 v[12:15], v[20:21], v[24:25], v[12:15]
  v_mfma_f32_16x16x16_bf16 v[16:19], v[20:21], v[26:27], v[16:19]
  v_and_b32_dpp v22, v28, v3 quad_perm:[3,3,3,3] row_mask:0xf bank_mask:0xf
  v_and_b32_dpp v23, v28, v4 quad_perm:[3,3,3,3] row_mask:0xf bank_mask:0xf
  ds_read_b128 v[24:27], v10 offset:5120
  s_waitcnt lgkmcnt(1)
  v_mfma_f32_16x16x16_bf16 v[12:15], v[22:23], v[36:37], v[12:15]
  v_mfma_f32_16x16x16_bf16 v[16:19], v[22:23], v[38:39], v[16:19]
  v_and_b32_dpp v20, v29, v3 quad_perm:[0,0,0,0] row_mask:0xf bank_mask:0xf
  v_and_b32_dpp v21, v29, v4 quad_perm:[0,0,0,0] row_mask:0xf bank_mask:0xf
  ds_read_b128 v[36:39], v10 offset:6144
  s_waitcnt lgkmcnt(1)
  v_mfma_f32_16x16x16_bf16 v[12:15], v[20:21], v[24:25], v[12:15]
  v_mfma_f32_16x16x16_bf16 v[16:19], v[20:21], v[26:27], v[16:19]
  v_and_b32_dpp v22, v29, v3 quad_perm:[1,1,1,1] row_mask:0xf bank_mask:0xf
  v_and_b32_dpp v23, v29, v4 quad_perm:[1,1,1,1] row_mask:0xf bank_mask:0xf
  ds_read_b128 v[24:27], v10 offset:7168
  s_waitcnt lgkmcnt(1)
  v_mfma_f32_16x16x16_bf16 v[12:15], v[22:23], v[36:37], v[12:15]
  v_mfma_f32_16x16x16_bf16 v[16:19], v[22:23], v[38:39], v[16:19]
  v_and_b32_dpp v20, v29, v3 quad_perm:[2,2,2,2] row_mask:0xf bank_mask:0xf
  v_and_b32_dpp v21, v29, v4 quad_perm:[2,2,2,2] row_mask:0xf bank_mask:0xf
  ds_read_b128 v[36:39], v10 offset:8192
  s_waitcnt lgkmcnt(1)
  v_mfma_f32_16x16x16_bf16 v[12:15], v[20:21], v[24:25], v[12:15]
  v_mfma_f32_16x16x16_bf16 v[16:19], v[20:21], v[26:27], v[16:19]
  v_and_b32_dpp v22, v29, v3 quad_perm:[3,3,3,3] row_mask:0xf bank_mask:0xf
  v_and_b32_dpp v23, v29, v4 quad_perm:[3,3,3,3] row_mask:0xf bank_mask:0xf
  ds_read_b128 v[24:27], v10 offset:9216
  s_waitcnt lgkmcnt(1)
  v_mfma_f32_16x16x16_bf16 v[12:15], v[22:23], v[36:37], v[12:15]
  v_mfma_f32_16x16x16_bf16 v[16:19], v[22:23], v[38:39], v[16:19]
  v_and_b32_dpp v20, v30, v3 quad_perm:[0,0,0,0] row_mask:0xf bank_mask:0xf
  v_and_b32_dpp v21, v30, v4 quad_perm:[0,0,0,0] row_mask:0xf bank_mask:0xf
  s_waitcnt lgkmcnt(0)
  s_nop 0
  v_mfma_f32_16x16x16_bf16 v[12:15], v[20:21], v[24:25], v[12:15]
  v_mfma_f32_16x16x16_bf16 v[16:19], v[20:21], v[26:27], v[16:19]
  v_and_b32_dpp v22, v30, v3 quad_perm:[1,1,1,1] row_mask:0xf bank_mask:0xf
  v_and_b32_dpp v23, v30, v4 quad_perm:[1,1,1,1] row_mask:0xf bank_mask:0xf
  s_waitcnt vmcnt(3)
  buffer_load_dwordx4 v[56:59], v2, s[52:55], s61 offen nt
  s_add_u32 s61, s61, 8192
  v_mfma_f32_16x16x16_bf16 v[12:15], v[22:23], v[40:41], v[12:15]
  v_mfma_f32_16x16x16_bf16 v[16:19], v[22:23], v[42:43], v[16:19]
  v_and_b32_dpp v20, v30, v3 quad_perm:[2,2,2,2] row_mask:0xf bank_mask:0xf
  v_and_b32_dpp v21, v30, v4 quad_perm:[2,2,2,2] row_mask:0xf bank_mask:0xf
  s_waitcnt vmcnt(3)
  buffer_load_dwordx4 v[60:63], v2, s[52:55], s61 offen nt
  s_add_u32 s61, s61, 8192
  v_mfma_f32_16x16x16_bf16 v[12:15], v[20:21], v[44:45], v[12:15]
  v_mfma_f32_16x16x16_bf16 v[16:19], v[20:21], v[46:47], v[16:19]
  v_and_b32_dpp v22, v30, v3 quad_perm:[3,3,3,3] row_mask:0xf bank_mask:0xf
  v_and_b32_dpp v23, v30, v4 quad_perm:[3,3,3,3] row_mask:0xf bank_mask:0xf
  s_waitcnt vmcnt(3)
  buffer_load_dwordx4 v[64:67], v2, s[52:55], s61 offen nt
  s_add_u32 s61, s61, 8192
  v_mfma_f32_16x16x16_bf16 v[12:15], v[22:23], v[48:49], v[12:15]
  v_mfma_f32_16x16x16_bf16 v[16:19], v[22:23], v[50:51], v[16:19]
  v_and_b32_dpp v20, v31, v3 quad_perm:[0,0,0,0] row_mask:0xf bank_mask:0xf
  v_and_b32_dpp v21, v31, v4 quad_perm:[0,0,0,0] row_mask:0xf bank_mask:0xf
  s_waitcnt vmcnt(3)
  buffer_load_dwordx4 v[68:71], v2, s[52:55], s61 offen nt
  s_add_u32 s61, s61, 8192
  v_mfma_f32_16x16x16_bf16 v[12:15], v[20:21], v[52:53], v[12:15]
  v_mfma_f32_16x16x16_bf16 v[16:19], v[20:21], v[54:55], v[16:19]
  v_and_b32_dpp v22, v31, v3 quad_perm:[1,1,1,1] row_mask:0xf bank_mask:0xf
  v_and_b32_dpp v23, v31, v4 quad_perm:[1,1,1,1] row_mask:0xf bank_mask:0xf
  s_waitcnt vmcnt(3)
  buffer_load_dwordx4 v[72:75], v2, s[52:55], s61 offen nt
  s_add_u32 s61, s61, 8192
  v_mfma_f32_16x16x16_bf16 v[12:15], v[22:23], v[56:57], v[12:15]
  v_mfma_f32_16x16x16_bf16 v[16:19], v[22:23], v[58:59], v[16:19]
  v_and_b32_dpp v20, v31, v3 quad_perm:[2,2,2,2] row_mask:0xf bank_mask:0xf
  v_and_b32_dpp v21, v31, v4 quad_perm:[2,2,2,2] row_mask:0xf bank_mask:0xf
  s_waitcnt vmcnt(3)
  buffer_load_dwordx4 v[76:79], v2, s[52:55], s61 offen nt
  s_add_u32 s61, s61, 8192
  v_mfma_f32_16x16x16_bf16 v[12:15], v[20:21], v[60:61], v[12:15]
  v_mfma_f32_16x16x16_bf16 v[16:19], v[20:21], v[62:63], v[16:19]
  v_and_b32_dpp v22, v31, v3 quad_perm:[3,3,3,3] row_mask:0xf bank_mask:0xf
  v_and_b32_dpp v23, v31, v4 quad_perm:[3,3,3,3] row_mask:0xf bank_mask:0xf
  s_waitcnt vmcnt(3)
  buffer_load_dwordx4 v[80:83], v2, s[52:55], s61 offen nt
  s_add_u32 s61, s61, 8192
  v_mfma_f32_16x16x16_bf16 v[12:15], v[22:23], v[64:65], v[12:15]
  v_mfma_f32_16x16x16_bf16 v[16:19], v[22:23], v[66:67], v[16:19]
  v_and_b32_dpp v20, v32, v3 quad_perm:[0,0,0,0] row_mask:0xf bank_mask:0xf
  v_and_b32_dpp v21, v32, v4 quad_perm:[0,0,0,0] row_mask:0xf bank_mask:0xf
  s_waitcnt vmcnt(3)
  buffer_load_dwordx4 v[84:87], v2, s[52:55], s61 offen nt
  s_add_u32 s61, s61, 8192
  v_mfma_f32_16x16x16_bf16 v[12:15], v[20:21], v[68:69], v[12:15]
  v_mfma_f32_16x16x16_bf16 v[16:19], v[20:21], v[70:71], v[16:19]
  v_and_b32_dpp v22, v32, v3 quad_perm:[1,1,1,1] row_mask:0xf bank_mask:0xf
  v_and_b32_dpp v23, v32, v4 quad_perm:[1,1,1,1] row_mask:0xf bank_mask:0xf
  s_waitcnt vmcnt(3)
  buffer_load_dwordx4 v[88:91], v2, s[52:55], s61 offen nt
  s_add_u32 s61, s61, 8192
  v_mfma_f32_16x16x16_bf16 v[12:15], v[22:23], v[72:73], v[12:15]
  v_mfma_f32_16x16x16_bf16 v[16:19], v[22:23], v[74:75], v[16:19]
  v_and_b32_dpp v20, v32, v3 quad_perm:[2,2,2,2] row_mask:0xf bank_mask:0xf
  v_and_b32_dpp v21, v32, v4 quad_perm:[2,2,2,2] row_mask:0xf bank_mask:0xf
  s_waitcnt vmcnt(3)
  buffer_load_dwordx4 v[92:95], v2, s[52:55], s61 offen nt
  s_add_u32 s61, s61, 8192
  v_mfma_f32_16x16x16_bf16 v[12:15], v[20:21], v[76:77], v[12:15]
  v_mfma_f32_16x16x16_bf16 v[16:19], v[20:21], v[78:79], v[16:19]
  v_and_b32_dpp v22, v32, v3 quad_perm:[3,3,3,3] row_mask:0xf bank_mask:0xf
  v_and_b32_dpp v23, v32, v4 quad_perm:[3,3,3,3] row_mask:0xf bank_mask:0xf
  s_waitcnt vmcnt(3)
  buffer_load_dwordx4 v[96:99], v2, s[52:55], s61 offen nt
  s_add_u32 s61, s61, 8192
  v_mfma_f32_16x16x16_bf16 v[12:15], v[22:23], v[80:81], v[12:15]
  v_mfma_f32_16x16x16_bf16 v[16:19], v[22:23], v[82:83], v[16:19]
  v_and_b32_dpp v20, v33, v3 quad_perm:[0,0,0,0] row_mask:0xf bank_mask:0xf
  v_and_b32_dpp v21, v33, v4 quad_perm:[0,0,0,0] row_mask:0xf bank_mask:0xf
  s_waitcnt vmcnt(3)
  buffer_load_dwordx4 v[100:103], v2, s[52:55], s61 offen nt
  s_add_u32 s61, s61, 8192
  v_mfma_f32_16x16x16_bf16 v[12:15], v[20:21], v[84:85], v[12:15]
  v_mfma_f32_16x16x16_bf16 v[16:19], v[20:21], v[86:87], v[16:19]
  v_and_b32_dpp v22, v33, v3 quad_perm:[1,1,1,1] row_mask:0xf bank_mask:0xf
  v_and_b32_dpp v23, v33, v4 quad_perm:[1,1,1,1] row_mask:0xf bank_mask:0xf
  s_waitcnt vmcnt(3)
  buffer_load_dwordx4 v[104:107], v2, s[52:55], s61 offen nt
  s_add_u32 s61, s61, 8192
  v_mfma_f32_16x16x16_bf16 v[12:15], v[22:23], v[88:89], v[12:15]
  v_mfma_f32_16x16x16_bf16 v[16:19], v[22:23], v[90:91], v[16:19]
  v_and_b32_dpp v20, v33, v3 quad_perm:[2,2,2,2] row_mask:0xf bank_mask:0xf
  v_and_b32_dpp v21, v33, v4 quad_perm:[2,2,2,2] row_mask:0xf bank_mask:0xf
  s_waitcnt vmcnt(3)
  buffer_load_dwordx4 v[108:111], v2, s[52:55], s61 offen nt
  s_add_u32 s61, s61, 8192
  v_mfma_f32_16x16x16_bf16 v[12:15], v[20:21], v[92:93], v[12:15]
  v_mfma_f32_16x16x16_bf16 v[16:19], v[20:21], v[94:95], v[16:19]
  v_and_b32_dpp v22, v33, v3 quad_perm:[3,3,3,3] row_mask:0xf bank_mask:0xf
  v_and_b32_dpp v23, v33, v4 quad_perm:[3,3,3,3] row_mask:0xf bank_mask:0xf
  s_waitcnt vmcnt(3)
  buffer_load_dwordx4 v[112:115], v2, s[52:55], s61 offen nt
  s_add_u32 s61, s61, 8192
  v_mfma_f32_16x16x16_bf16 v[12:15], v[22:23], v[96:97], v[12:15]
  v_mfma_f32_16x16x16_bf16 v[16:19], v[22:23], v[98:99], v[16:19]
  v_and_b32_dpp v20, v34, v3 quad_perm:[0,0,0,0] row_mask:0xf bank_mask:0xf
  v_and_b32_dpp v21, v34, v4 quad_perm:[0,0,0,0] row_mask:0xf bank_mask:0xf
  s_waitcnt vmcnt(3)
  buffer_load_dwordx4 v[116:119], v2, s[52:55], s61 offen nt
  s_add_u32 s61, s61, 8192
  v_mfma_f32_16x16x16_bf16 v[12:15], v[20:21], v[100:101], v[12:15]
  v_mfma_f32_16x16x16_bf16 v[16:19], v[20:21], v[102:103], v[16:19]
  v_and_b32_dpp v22, v34, v3 quad_perm:[1,1,1,1] row_mask:0xf bank_mask:0xf
  v_and_b32_dpp v23, v34, v4 quad_perm:[1,1,1,1] row_mask:0xf bank_mask:0xf
  s_waitcnt vmcnt(3)
  buffer_load_dwordx4 v[120:123], v2, s[52:55], s61 offen nt
  s_add_u32 s61, s61, 8192
  v_mfma_f32_16x16x16_bf16 v[12:15], v[22:23], v[104:105], v[12:15]
  v_mfma_f32_16x16x16_bf16 v[16:19], v[22:23], v[106:107], v[16:19]
  v_and_b32_dpp v20, v34, v3 quad_perm:[2,2,2,2] row_mask:0xf bank_mask:0xf
  v_and_b32_dpp v21, v34, v4 quad_perm:[2,2,2,2] row_mask:0xf bank_mask:0xf
  s_waitcnt vmcnt(3)
  buffer_load_dwordx4 v[124:127], v2, s[52:55], s61 offen nt
  s_add_u32 s61, s61, 8192
  v_mfma_f32_16x16x16_bf16 v[12:15], v[20:21], v[108:109], v[12:15]
  v_mfma_f32_16x16x16_bf16 v[16:19], v[20:21], v[110:111], v[16:19]
L_cm_7:
  ds_read_b32 v161, v162
  s_waitcnt lgkmcnt(0)
  v_readfirstlane_b32 s62, v161
  s_add_u32 s80, s80, 1
  s_cmp_gt_u32 s80, 400000
  s_cbranch_scc1 L_abort
  s_cmp_lt_u32 s62, 8
  s_cbranch_scc1 L_cm_7
  ds_read_b32 v160, v155
  ds_read_b32 v161, v156
  ds_read_b32 v164, v154
  s_waitcnt lgkmcnt(0)
  v_sub_f32 v160, v160, v161
  v_sub_f32 v164, v8, v164
  v_exp_f32 v160, v160
  v_exp_f32 v164, v164
  s_nop 0
  v_mul_f32 v164, v9, v164
  s_mov_b64 exec, s[68:69]
  ds_add_f32 v154, v164 offset:16
  s_mov_b64 exec, -1
  v_and_b32_dpp v22, v34, v3 quad_perm:[3,3,3,3] row_mask:0xf bank_mask:0xf
  v_and_b32_dpp v23, v34, v4 quad_perm:[3,3,3,3] row_mask:0xf bank_mask:0xf
  s_waitcnt vmcnt(3)
  buffer_load_dwordx4 v[128:131], v2, s[52:55], s61 offen nt
  s_add_u32 s61, s61, 8192
  v_mfma_f32_16x16x16_bf16 v[12:15], v[22:23], v[112:113], v[12:15]
  v_mfma_f32_16x16x16_bf16 v[16:19], v[22:23], v[114:115], v[16:19]
  v_and_b32_dpp v20, v35, v3 quad_perm:[0,0,0,0] row_mask:0xf bank_mask:0xf
  v_and_b32_dpp v21, v35, v4 quad_perm:[0,0,0,0] row_mask:0xf bank_mask:0xf
  s_waitcnt vmcnt(3)
  buffer_load_dwordx4 v[132:135], v2, s[52:55], s61 offen nt
  v_mfma_f32_16x16x16_bf16 v[12:15], v[20:21], v[116:117], v[12:15]
  v_mfma_f32_16x16x16_bf16 v[16:19], v[20:21], v[118:119], v[16:19]
  v_and_b32_dpp v22, v35, v3 quad_perm:[1,1,1,1] row_mask:0xf bank_mask:0xf
  v_and_b32_dpp v23, v35, v4 quad_perm:[1,1,1,1] row_mask:0xf bank_mask:0xf
  s_waitcnt vmcnt(3)
  s_nop 0
  v_mfma_f32_16x16x16_bf16 v[12:15], v[22:23], v[120:121], v[12:15]
  v_mfma_f32_16x16x16_bf16 v[16:19], v[22:23], v[122:123], v[16:19]
  v_and_b32_dpp v20, v35, v3 quad_perm:[2,2,2,2] row_mask:0xf bank_mask:0xf
  v_and_b32_dpp v21, v35, v4 quad_perm:[2,2,2,2] row_mask:0xf bank_mask:0xf
  s_waitcnt vmcnt(2)
  s_nop 0
  v_mfma_f32_16x16x16_bf16 v[12:15], v[20:21], v[124:125], v[12:15]
  v_mfma_f32_16x16x16_bf16 v[16:19], v[20:21], v[126:127], v[16:19]
  v_and_b32_dpp v22, v35, v3 quad_perm:[3,3,3,3] row_mask:0xf bank_mask:0xf
  v_and_b32_dpp v23, v35, v4 quad_perm:[3,3,3,3] row_mask:0xf bank_mask:0xf
  s_waitcnt vmcnt(1)
  s_nop 0
  v_mfma_f32_16x16x16_bf16 v[12:15], v[22:23], v[128:129], v[12:15]
  v_mfma_f32_16x16x16_bf16 v[16:19], v[22:23], v[130:131], v[16:19]
  v_and_b32_dpp v20, v7, v3 quad_perm:[0,0,0,0] row_mask:0xf bank_mask:0xf
  v_and_b32_dpp v21, v7, v4 quad_perm:[0,0,0,0] row_mask:0xf bank_mask:0xf
  s_waitcnt vmcnt(0)
  s_nop 0
  v_mfma_f32_16x16x16_bf16 v[12:15], v[20:21], v[132:133], v[12:15]
  v_mfma_f32_16x16x16_bf16 v[16:19], v[20:21], v[134:135], v[16:19]
  s_branch L_att_done
L_att_28_2_0_0_0:
  s_lshl_b32 s60, s36, 23
  s_lshl_b32 s61, s62, 13
  s_add_u32 s60, s60, s61
  s_lshl_b32 s61, s3, 10
  s_add_u32 s60, s60, s61
  s_mov_b32 s61, s60
  s_barrier
  buffer_load_dwordx4 v[40:43], v1, s[48:51], s60 offen nt
  s_add_u32 s60, s60, 8192
  buffer_load_dwordx4 v[44:47], v1, s[48:51], s60 offen nt
  s_add_u32 s60, s60, 8192
  buffer_load_dwordx4 v[48:51], v1, s[48:51], s60 offen nt
  s_add_u32 s60, s60, 8192
  s_waitcnt vmcnt(2)
  buffer_load_dwordx4 v[52:55], v1, s[48:51], s60 offen nt
  s_add_u32 s60, s60, 8192
  s_waitcnt vmcnt(2)
  buffer_load_dwordx4 v[56:59], v1, s[48:51], s60 offen nt
  s_add_u32 s60, s60, 8192
  s_waitcnt vmcnt(2)
  buffer_load_dwordx4 v[60:63], v1, s[48:51], s60 offen nt
  s_add_u32 s60, s60, 8192
  s_waitcnt vmcnt(2)
  buffer_load_dwordx4 v[64:67], v1, s[48:51], s60 offen nt
  s_add_u32 s60, s60, 8192
  s_waitcnt vmcnt(2)
  buffer_load_dwordx4 v[68:71], v1, s[48:51], s60 offen nt
  s_add_u32 s60, s60, 8192
  s_waitcnt vmcnt(2)
  buffer_load_dwordx4 v[72:75], v1, s[48:51], s60 offen nt
  s_add_u32 s60, s60, 8192
  s_waitcnt vmcnt(2)
  buffer_load_dwordx4 v[76:79], v1, s[48:51], s60 offen nt
  s_add_u32 s60, s60, 8192
  s_waitcnt vmcnt(2)
  buffer_load_dwordx4 v[80:83], v1, s[48:51], s60 offen nt
  s_add_u32 s60, s60, 8192
  s_waitcnt vmcnt(2)
  buffer_load_dwordx4 v[84:87], v1, s[48:51], s60 offen nt
  s_add_u32 s60, s60, 8192
  s_waitcnt vmcnt(2)
  buffer_load_dwordx4 v[88:91], v1, s[48:51], s60 offen nt
  s_add_u32 s60, s60, 8192
  s_waitcnt vmcnt(2)
  buffer_load_dwordx4 v[92:95], v1, s[48:51], s60 offen nt
  s_add_u32 s60, s60, 8192
  s_waitcnt vmcnt(2)
  buffer_load_dwordx4 v[96:99], v1, s[48:51], s60 offen nt
  s_add_u32 s60, s60, 8192
  s_waitcnt vmcnt(2)
  buffer_load_dwordx4 v[100:103], v1, s[48:51], s60 offen nt
  s_add_u32 s60, s60, 8192
  s_waitcnt vmcnt(2)
  buffer_load_dwordx4 v[104:107], v1, s[48:51], s60 offen nt
  s_add_u32 s60, s60, 8192
  s_waitcnt vmcnt(2)
  buffer_load_dwordx4 v[108:111], v1, s[48:51], s60 offen nt
  s_add_u32 s60, s60, 8192
  s_waitcnt vmcnt(2)
  buffer_load_dwordx4 v[112:115], v1, s[48:51], s60 offen nt
  s_add_u32 s60, s60, 8192
  s_waitcnt vmcnt(2)
  buffer_load_dwordx4 v[116:119], v1, s[48:51], s60 offen nt
  s_add_u32 s60, s60, 8192
  s_waitcnt vmcnt(2)
  buffer_load_dwordx4 v[120:123], v1, s[48:51], s60 offen nt
  s_add_u32 s60, s60, 8192
  s_waitcnt vmcnt(2)
  buffer_load_dwordx4 v[124:127], v1, s[48:51], s60 offen nt
  s_add_u32 s60, s60, 8192
  s_waitcnt vmcnt(2)
  buffer_load_dwordx4 v[128:131], v1, s[48:51], s60 offen nt
  s_add_u32 s60, s60, 8192
  s_waitcnt vmcnt(2)
  buffer_load_dwordx4 v[132:135], v1, s[48:51], s60 offen nt
  s_add_u32 s60, s60, 8192
  s_waitcnt vmcnt(2)
  buffer_load_dwordx4 v[136:139], v1, s[48:51], s60 offen nt
  s_add_u32 s60, s60, 8192
  s_waitcnt vmcnt(2)
  buffer_load_dwordx4 v[140:143], v1, s[48:51], s60 offen nt
  s_add_u32 s60, s60, 8192
  s_waitcnt vmcnt(2)
  buffer_load_dwordx4 v[144:147], v1, s[48:51], s60 offen nt
  s_add_u32 s60, s60, 8192
  s_waitcnt vmcnt(2)
  buffer_load_dwordx4 v[148:151], v1, s[48:51], s60 offen nt
  s_waitcnt vmcnt(2)
  s_add_u32 m0, s63, 0
  s_nop 0
  buffer_load_dwordx4 v2, s[52:55], s61 offen nt lds
  s_add_u32 s61, s61, 8192
  s_waitcnt vmcnt(2)
  s_add_u32 m0, s63, 1024
  s_nop 0
  buffer_load_dwordx4 v2, s[52:55], s61 offen nt lds
  s_add_u32 s61, s61, 8192
  s_waitcnt vmcnt(2)
  s_add_u32 m0, s63, 2048
  s_nop 0
  buffer_load_dwordx4 v2, s[52:55], s61 offen nt lds
  s_add_u32 s61, s61, 8192
  s_waitcnt vmcnt(2)
  s_add_u32 m0, s63, 3072
  s_nop 0
  buffer_load_dwordx4 v2, s[52:55], s61 offen nt lds
  s_add_u32 s61, s61, 8192
  s_waitcnt vmcnt(2)
  s_add_u32 m0, s63, 4096
  s_nop 0
  buffer_load_dwordx4 v2, s[52:55], s61 offen nt lds
  s_add_u32 s61, s61, 8192
  s_waitcnt vmcnt(2)
  s_add_u32 m0, s63, 5120
  s_nop 0
  buffer_load_dwordx4 v2, s[52:55], s61 offen nt lds
  s_add_u32 s61, s61, 8192
  s_waitcnt vmcnt(2)
  s_add_u32 m0, s63, 6144
  s_nop 0
  buffer_load_dwordx4 v2, s[52:55], s61 offen nt lds
  s_add_u32 s61, s61, 8192
  s_waitcnt vmcnt(2)
  s_add_u32 m0, s63, 7168
  s_nop 0
  buffer_load_dwordx4 v2, s[52:55], s61 offen nt lds
  s_add_u32 s61, s61, 8192
  s_waitcnt vmcnt(2)
  s_add_u32 m0, s63, 8192
  s_nop 0
  buffer_load_dwordx4 v2, s[52:55], s61 offen nt lds
  s_add_u32 s61, s61, 8192
  s_waitcnt vmcnt(2)
  s_add_u32 m0, s63, 9216
  s_nop 0
  buffer_load_dwordx4 v2, s[52:55], s61 offen nt lds
  s_add_u32 s61, s61, 8192
  s_waitcnt vmcnt(2)
  s_barrier
  ds_read_b128 v[8:11], v6
  v_mov_b32 v12, 153064
  ds_read_b32 v13, v12
  s_waitcnt lgkmcnt(0)
  v_readfirstlane_b32 s75, v13
  v_mfma_f32_16x16x32_bf16 v[12:15], v[40:43], v[8:11], 0
  v_mfma_f32_16x16x32_bf16 v[16:19], v[44:47], v[8:11], 0
  v_mfma_f32_16x16x32_bf16 v[20:23], v[48:51], v[8:11], 0
  v_mfma_f32_16x16x32_bf16 v[24:27], v[52:55], v[8:11], 0
  buffer_load_dwordx4 v[40:43], v2, s[52:55], s61 offen nt
  s_add_u32 s61, s61, 8192
  buffer_load_dwordx4 v[44:47], v2, s[52:55], s61 offen nt
  s_add_u32 s61, s61, 8192
  buffer_load_dwordx4 v[48:51], v2, s[52:55], s61 offen nt
  s_add_u32 s61, s61, 8192
  v_cndmask_b32 v36, v12, v17, s[56:57]
  s_nop 0
  v_cndmask_b32 v37, v22, v27, s[56:57]
  v_cndmask_b32 v28, v36, v37, s[58:59]
  v_cndmask_b32 v36, v16, v13, s[56:57]
  v_cndmask_b32 v37, v26, v23, s[56:57]
  v_cndmask_b32 v39, v36, v37, s[58:59]
  s_nop 1
  v_add_f32_dpp v28, v39, v28 quad_perm:[1,0,3,2] row_mask:0xf bank_mask:0xf
  v_cndmask_b32 v36, v20, v25, s[56:57]
  v_cndmask_b32 v37, v14, v19, s[56:57]
  v_cndmask_b32 v38, v36, v37, s[58:59]
  s_nop 1
  v_add_f32_dpp v28, v38, v28 quad_perm:[2,3,0,1] row_mask:0xf bank_mask:0xf
  v_cndmask_b32 v36, v24, v21, s[56:57]
  v_cndmask_b32 v37, v18, v15, s[56:57]
  v_cndmask_b32 v39, v36, v37, s[58:59]
  s_nop 1
  v_add_f32_dpp v28, v39, v28 quad_perm:[3,2,1,0] row_mask:0xf bank_mask:0xf
  v_mfma_f32_16x16x32_bf16 v[12:15], v[56:59], v[8:11], 0
  v_mfma_f32_16x16x32_bf16 v[16:19], v[60:63], v[8:11], 0
  v_mfma_f32_16x16x32_bf16 v[20:23], v[64:67], v[8:11], 0
  v_mfma_f32_16x16x32_bf16 v[24:27], v[68:71], v[8:11], 0
  s_nop 5
  v_cndmask_b32 v36, v12, v17, s[56:57]
  s_nop 0
  v_cndmask_b32 v37, v22, v27, s[56:57]
  v_cndmask_b32 v29, v36, v37, s[58:59]
  v_cndmask_b32 v36, v16, v13, s[56:57]
  v_cndmask_b32 v37, v26, v23, s[56:57]
  v_cndmask_b32 v39, v36, v37, s[58:59]
  s_nop 1
  v_add_f32_dpp v29, v39, v29 quad_perm:[1,0,3,2] row_mask:0xf bank_mask:0xf
  v_cndmask_b32 v36, v20, v25, s[56:57]
  v_cndmask_b32 v37, v14, v19, s[56:57]
  v_cndmask_b32 v38, v36, v37, s[58:59]
  s_nop 1
  v_add_f32_dpp v29, v38, v29 quad_perm:[2,3,0,1] row_mask:0xf bank_mask:0xf
  v_cndmask_b32 v36, v24, v21, s[56:57]
  v_cndmask_b32 v37, v18, v15, s[56:57]
  v_cndmask_b32 v39, v36, v37, s[58:59]
  s_nop 1
  v_add_f32_dpp v29, v39, v29 quad_perm:[3,2,1,0] row_mask:0xf bank_mask:0xf
  v_mfma_f32_16x16x32_bf16 v[12:15], v[72:75], v[8:11], 0
  v_mfma_f32_16x16x32_bf16 v[16:19], v[76:79], v[8:11], 0
  v_mfma_f32_16x16x32_bf16 v[20:23], v[80:83], v[8:11], 0
  v_mfma_f32_16x16x32_bf16 v[24:27], v[84:87], v[8:11], 0
  s_nop 5
  v_cndmask_b32 v36, v12, v17, s[56:57]
  s_nop 0
  v_cndmask_b32 v37, v22, v27, s[56:57]
  v_cndmask_b32 v30, v36, v37, s[58:59]
  v_cndmask_b32 v36, v16, v13, s[56:57]
  v_cndmask_b32 v37, v26, v23, s[56:57]
  v_cndmask_b32 v39, v36, v37, s[58:59]
  s_nop 1
  v_add_f32_dpp v30, v39, v30 quad_perm:[1,0,3,2] row_mask:0xf bank_mask:0xf
  v_cndmask_b32 v36, v20, v25, s[56:57]
  v_cndmask_b32 v37, v14, v19, s[56:57]
  v_cndmask_b32 v38, v36, v37, s[58:59]
  s_nop 1
  v_add_f32_dpp v30, v38, v30 quad_perm:[2,3,0,1] row_mask:0xf bank_mask:0xf
  v_cndmask_b32 v36, v24, v21, s[56:57]
  v_cndmask_b32 v37, v18, v15, s[56:57]
  v_cndmask_b32 v39, v36, v37, s[58:59]
  s_nop 1
  v_add_f32_dpp v30, v39, v30 quad_perm:[3,2,1,0] row_mask:0xf bank_mask:0xf
  v_mfma_f32_16x16x32_bf16 v[12:15], v[88:91], v[8:11], 0
  v_mfma_f32_16x16x32_bf16 v[16:19], v[92:95], v[8:11], 0
  v_mfma_f32_16x16x32_bf16 v[20:23], v[96:99], v[8:11], 0
  v_mfma_f32_16x16x32_bf16 v[24:27], v[100:103], v[8:11], 0
  s_nop 5
  v_cndmask_b32 v36, v12, v17, s[56:57]
  s_nop 0
  v_cndmask_b32 v37, v22, v27, s[56:57]
  v_cndmask_b32 v31, v36, v37, s[58:59]
  v_cndmask_b32 v36, v16, v13, s[56:57]
  v_cndmask_b32 v37, v26, v23, s[56:57]
  v_cndmask_b32 v39, v36, v37, s[58:59]
  s_nop 1
  v_add_f32_dpp v31, v39, v31 quad_perm:[1,0,3,2] row_mask:0xf bank_mask:0xf
  v_cndmask_b32 v36, v20, v25, s[56:57]
  v_cndmask_b32 v37, v14, v19, s[56:57]
  v_cndmask_b32 v38, v36, v37, s[58:59]
  s_nop 1
  v_add_f32_dpp v31, v38, v31 quad_perm:[2,3,0,1] row_mask:0xf bank_mask:0xf
  v_cndmask_b32 v36, v24, v21, s[56:57]
  v_cndmask_b32 v37, v18, v15, s[56:57]
  v_cndmask_b32 v39, v36, v37, s[58:59]
  s_nop 1
  v_add_f32_dpp v31, v39, v31 quad_perm:[3,2,1,0] row_mask:0xf bank_mask:0xf
  v_mfma_f32_16x16x32_bf16 v[12:15], v[104:107], v[8:11], 0
  v_mfma_f32_16x16x32_bf16 v[16:19], v[108:111], v[8:11], 0
  v_mfma_f32_16x16x32_bf16 v[20:23], v[112:115], v[8:11], 0
  v_mfma_f32_16x16x32_bf16 v[24:27], v[116:119], v[8:11], 0
  buffer_load_dwordx4 v[52:55], v2, s[52:55], s61 offen nt
  s_add_u32 s61, s61, 8192
  s_nop 3
  v_cndmask_b32 v36, v12, v17, s[56:57]
  s_nop 0
  v_cndmask_b32 v37, v22, v27, s[56:57]
  v_cndmask_b32 v32, v36, v37, s[58:59]
  v_cndmask_b32 v36, v16, v13, s[56:57]
  v_cndmask_b32 v37, v26, v23, s[56:57]
  v_cndmask_b32 v39, v36, v37, s[58:59]
  s_nop 1
  v_add_f32_dpp v32, v39, v32 quad_perm:[1,0,3,2] row_mask:0xf bank_mask:0xf
  v_cndmask_b32 v36, v20, v25, s[56:57]
  v_cndmask_b32 v37, v14, v19, s[56:57]
  v_cndmask_b32 v38, v36, v37, s[58:59]
  s_nop 1
  v_add_f32_dpp v32, v38, v32 quad_perm:[2,3,0,1] row_mask:0xf bank_mask:0xf
  v_cndmask_b32 v36, v24, v21, s[56:57]
  v_cndmask_b32 v37, v18, v15, s[56:57]
  v_cndmask_b32 v39, v36, v37, s[58:59]
  s_nop 1
  v_add_f32_dpp v32, v39, v32 quad_perm:[3,2,1,0] row_mask:0xf bank_mask:0xf
  v_mfma_f32_16x16x32_bf16 v[12:15], v[120:123], v[8:11], 0
  v_mfma_f32_16x16x32_bf16 v[16:19], v[124:127], v[8:11], 0
  v_mfma_f32_16x16x32_bf16 v[20:23], v[128:131], v[8:11], 0
  v_mfma_f32_16x16x32_bf16 v[24:27], v[132:135], v[8:11], 0
  s_nop 5
  v_cndmask_b32 v36, v12, v17, s[56:57]
  s_nop 0
  v_cndmask_b32 v37, v22, v27, s[56:57]
  v_cndmask_b32 v33, v36, v37, s[58:59]
  v_cndmask_b32 v36, v16, v13, s[56:57]
  v_cndmask_b32 v37, v26, v23, s[56:57]
  v_cndmask_b32 v39, v36, v37, s[58:59]
  s_nop 1
  v_add_f32_dpp v33, v39, v33 quad_perm:[1,0,3,2] row_mask:0xf bank_mask:0xf
  v_cndmask_b32 v36, v20, v25, s[56:57]
  v_cndmask_b32 v37, v14, v19, s[56:57]
  v_cndmask_b32 v38, v36, v37, s[58:59]
  s_nop 1
  v_add_f32_dpp v33, v38, v33 quad_perm:[2,3,0,1] row_mask:0xf bank_mask:0xf
  v_cndmask_b32 v36, v24, v21, s[56:57]
  v_cndmask_b32 v37, v18, v15, s[56:57]
  v_cndmask_b32 v39, v36, v37, s[58:59]
  s_nop 1
  v_add_f32_dpp v33, v39, v33 quad_perm:[3,2,1,0] row_mask:0xf bank_mask:0xf
  v_mfma_f32_16x16x32_bf16 v[12:15], v[136:139], v[8:11], 0
  v_mfma_f32_16x16x32_bf16 v[16:19], v[140:143], v[8:11], 0
  v_mfma_f32_16x16x32_bf16 v[20:23], v[144:147], v[8:11], 0
  v_mfma_f32_16x16x32_bf16 v[24:27], v[148:151], v[8:11], 0
  s_nop 5
  v_cndmask_b32 v36, v12, v17, s[56:57]
  s_nop 0
  v_cndmask_b32 v37, v22, v27, s[56:57]
  v_cndmask_b32 v34, v36, v37, s[58:59]
  v_cndmask_b32 v36, v16, v13, s[56:57]
  v_cndmask_b32 v37, v26, v23, s[56:57]
  v_cndmask_b32 v39, v36, v37, s[58:59]
  s_nop 1
  v_add_f32_dpp v34, v39, v34 quad_perm:[1,0,3,2] row_mask:0xf bank_mask:0xf
  v_cndmask_b32 v36, v20, v25, s[56:57]
  v_cndmask_b32 v37, v14, v19, s[56:57]
  v_cndmask_b32 v38, v36, v37, s[58:59]
  s_nop 1
  v_add_f32_dpp v34, v38, v34 quad_perm:[2,3,0,1] row_mask:0xf bank_mask:0xf
  v_cndmask_b32 v36, v24, v21, s[56:57]
  v_cndmask_b32 v37, v18, v15, s[56:57]
  v_cndmask_b32 v39, v36, v37, s[58:59]
  s_nop 1
  v_add_f32_dpp v34, v39, v34 quad_perm:[3,2,1,0] row_mask:0xf bank_mask:0xf
  v_cvt_pk_bf16_f32 v36, v28, v29
  v_lshlrev_b32 v28, 16, v36
  v_and_b32 v29, 0xffff0000, v36
  v_cvt_pk_bf16_f32 v37, v30, v31
  v_lshlrev_b32 v30, 16, v37
  v_and_b32 v31, 0xffff0000, v37
  v_cvt_pk_bf16_f32 v36, v32, v33
  v_lshlrev_b32 v32, 16, v36
  v_and_b32 v33, 0xffff0000, v36
  v_cvt_pk_bf16_f32 v36, v34, v34
  v_lshlrev_b32 v34, 16, v36
  s_mov_b32 s62, 0x3db504f3
  v_mul_f32 v28, s62, v28
  v_mul_f32 v29, s62, v29
  v_mul_f32 v30, s62, v30
  v_mul_f32 v31, s62, v31
  v_mul_f32 v32, s62, v32
  v_mul_f32 v33, s62, v33
  v_mul_f32 v34, s62, v34
  v_cvt_pk_bf16_f32 v36, v28, v29
  v_lshlrev_b32 v28, 16, v36
  v_and_b32 v29, 0xffff0000, v36
  v_cvt_pk_bf16_f32 v37, v30, v31
  v_lshlrev_b32 v30, 16, v37
  v_and_b32 v31, 0xffff0000, v37
  v_cvt_pk_bf16_f32 v36, v32, v33
  v_lshlrev_b32 v32, 16, v36
  v_and_b32 v33, 0xffff0000, v36
  v_cvt_pk_bf16_f32 v36, v34, v34
  v_lshlrev_b32 v34, 16, v36
  v_max_f32 v8, v28, v29
  v_max3_f32 v8, v8, v30, v31
  v_max3_f32 v8, v8, v32, v33
  v_max_f32 v8, v8, v34
  s_nop 1
  v_max_f32_dpp v8, v8, v8 quad_perm:[1,0,3,2] row_mask:0xf bank_mask:0xf
  s_nop 1
  v_max_f32_dpp v8, v8, v8 quad_perm:[2,3,0,1] row_mask:0xf bank_mask:0xf
  v_mov_b32 v36, v8
  s_nop 1
  v_permlane16_swap_b32 v8, v36
  v_max_f32 v8, v8, v36
  v_mov_b32 v36, v8
  s_nop 1
  v_permlane32_swap_b32 v8, v36
  v_max_f32 v8, v8, v36
  s_mov_b32 s62, 0x3fb8aa3b
  v_mul_f32 v8, s62, v8
  v_fma_f32 v28, v28, s62, -v8
  v_fma_f32 v29, v29, s62, -v8
  v_fma_f32 v30, v30, s62, -v8
  v_fma_f32 v31, v31, s62, -v8
  v_fma_f32 v32, v32, s62, -v8
  v_fma_f32 v33, v33, s62, -v8
  v_fma_f32 v34, v34, s62, -v8
  v_exp_f32 v28, v28
  v_exp_f32 v29, v29
  v_exp_f32 v30, v30
  v_exp_f32 v31, v31
  v_exp_f32 v32, v32
  v_exp_f32 v33, v33
  v_exp_f32 v34, v34
  v_add_f32 v9, v28, v29
  v_add_f32 v9, v9, v30
  v_add_f32 v9, v9, v31
  v_add_f32 v9, v9, v32
  v_add_f32 v9, v9, v33
  v_add_f32 v9, v9, v34
  v_cvt_pk_bf16_f32 v28, v28, v28
  v_cvt_pk_bf16_f32 v29, v29, v29
  v_cvt_pk_bf16_f32 v30, v30, v30
  v_cvt_pk_bf16_f32 v31, v31, v31
  v_cvt_pk_bf16_f32 v32, v32, v32
  v_cvt_pk_bf16_f32 v33, v33, v33
  v_cvt_pk_bf16_f32 v34, v34, v34
  v_add_f32_dpp v9, v9, v9 quad_perm:[1,0,3,2] row_mask:0xf bank_mask:0xf
  s_nop 1
  v_add_f32_dpp v9, v9, v9 quad_perm:[2,3,0,1] row_mask:0xf bank_mask:0xf
  v_mov_b32 v36, v9
  s_nop 1
  v_permlane16_swap_b32 v9, v36
  v_add_f32 v9, v9, v36
  v_mov_b32 v36, v9
  s_nop 1
  v_permlane32_swap_b32 v9, v36
  v_add_f32 v9, v9, v36
  v_lshlrev_b32 v152, 5, v0
  v_add_u32 v152, s63, v152
  v_bfe_u32 v165, v0, 2, 2
  s_lshl_b32 s62, s3, 2
  s_add_u32 s62, s62, 147456
  v_lshlrev_b32 v153, 5, v165
  v_add_u32 v153, s62, v153
  v_lshlrev_b32 v154, 2, v165
  v_add_u32 v154, 153024, v154
  v_lshrrev_b32 v165, 4, v0
  v_lshlrev_b32 v155, 5, v165
  v_add_u32 v155, s62, v155
  v_lshlrev_b32 v156, 2, v165
  v_add_u32 v156, 153024, v156
  v_and_b32 v166, 0x33, v0
  v_cmp_eq_u32 s[68:69], 0, v166
  v_mov_b32 v162, 153056
  v_mov_b32 v163, 1
  s_mov_b64 exec, s[68:69]
  ds_write_b32 v153, v8
  ds_max_f32 v154, v8
  s_mov_b64 exec, 1
  ds_add_u32 v162, v163
  s_mov_b64 exec, -1
  v_and_b32 v166, 15, v0
  v_lshrrev_b32 v157, 2, v166
  v_lshlrev_b32 v157, 12, v157
  v_and_b32 v167, 3, v166
  v_lshl_add_u32 v157, v167, 5, v157
  v_and_b32 v164, 1, v165
  v_lshl_add_u32 v157, v164, 4, v157
  v_and_b32 v158, 1, v166
  v_lshlrev_b32 v158, 4, v158
  v_lshl_add_u32 v158, v164, 3, v158
  v_lshrrev_b32 v159, 2, v166
  v_lshl_add_u32 v158, v159, 6, v158
  v_lshrrev_b32 v159, 1, v167
  v_lshl_add_u32 v158, v159, 5, v158
  v_lshrrev_b32 v159, 5, v0
  s_mov_b32 s62, 40960
  v_mul_lo_u32 v159, v159, s62
  v_add_u32 v158, v158, v159
  s_lshr_b32 s62, s3, 1
  s_lshl_b32 s62, s62, 9
  s_and_b32 s64, s3, 1
  s_lshl_b32 s64, s64, 8
  s_add_u32 s62, s62, s64
  s_add_u32 s62, s62, 65536
  v_add_u32 v158, s62, v158
  s_lshr_b32 s62, s3, 1
  s_lshl_b32 s62, s62, 2
  s_add_u32 s62, s62, 153024
  v_mov_b32 v159, s62
  s_lshl_b32 s66, s36, 5
  s_lshl_b32 s62, s3, 2
  s_add_u32 s66, s66, s62
  s_lshl_b32 s66, s66, 5
  s_add_u32 s66, s66, s37
  s_lshl_b32 s66, s66, 7
  s_add_u32 s67, s66, 5242880
  v_add_u32 v10, s63, v2
  s_waitcnt vmcnt(5)
  s_waitcnt vmcnt(4)
  ds_read_b128 v[24:27], v10 offset:0
  v_and_b32_dpp v20, v28, v3 quad_perm:[0,0,0,0] row_mask:0xf bank_mask:0xf
  v_and_b32_dpp v21, v28, v4 quad_perm:[0,0,0,0] row_mask:0xf bank_mask:0xf
  ds_read_b128 v[36:39], v10 offset:1024
  s_waitcnt lgkmcnt(1)
  v_mfma_f32_16x16x16_bf16 v[12:15], v[20:21], v[24:25], 0
  v_mfma_f32_16x16x16_bf16 v[16:19], v[20:21], v[26:27], 0
  v_and_b32_dpp v22, v28, v3 quad_perm:[1,1,1,1] row_mask:0xf bank_mask:0xf
  v_and_b32_dpp v23, v28, v4 quad_perm:[1,1,1,1] row_mask:0xf bank_mask:0xf
  ds_read_b128 v[24:27], v10 offset:2048
  s_waitcnt lgkmcnt(1)
  v_mfma_f32_16x16x16_bf16 v[12:15], v[22:23], v[36:37], v[12:15]
  v_mfma_f32_16x16x16_bf16 v[16:19], v[22:23], v[38:39], v[16:19]
  v_and_b32_dpp v20, v28, v3 quad_perm:[2,2,2,2] row_mask:0xf bank_mask:0xf
  v_and_b32_dpp v21, v28, v4 quad_perm:[2,2,2,2] row_mask:0xf bank_mask:0xf
  ds_read_b128 v[36:39], v10 offset:3072
  s_waitcnt lgkmcnt(1)
  v_mfma_f32_16x16x16_bf16 v[12:15], v[20:21], v[24:25], v[12:15]
  v_mfma_f32_16x16x16_bf16 v[16:19], v[20:21], v[26:27], v[16:19]
  v_and_b32_dpp v22, v28, v3 quad_perm:[3,3,3,3] row_mask:0xf bank_mask:0xf
  v_and_b32_dpp v23, v28, v4 quad_perm:[3,3,3,3] row_mask:0xf bank_mask:0xf
  ds_read_b128 v[24:27], v10 offset:4096
  s_waitcnt lgkmcnt(1)
  v_mfma_f32_16x16x16_bf16 v[12:15], v[22:23], v[36:37], v[12:15]
  v_mfma_f32_16x16x16_bf16 v[16:19], v[22:23], v[38:39], v[16:19]
  v_and_b32_dpp v20, v29, v3 quad_perm:[0,0,0,0] row_mask:0xf bank_mask:0xf
  v_and_b32_dpp v21, v29, v4 quad_perm:[0,0,0,0] row_mask:0xf bank_mask:0xf
  ds_read_b128 v[36:39], v10 offset:5120
  s_waitcnt lgkmcnt(1)
  v_mfma_f32_16x16x16_bf16 v[12:15], v[20:21], v[24:25], v[12:15]
  v_mfma_f32_16x16x16_bf16 v[16:19], v[20:21], v[26:27], v[16:19]
  v_and_b32_dpp v22, v29, v3 quad_perm:[1,1,1,1] row_mask:0xf bank_mask:0xf
  v_and_b32_dpp v23, v29, v4 quad_perm:[1,1,1,1] row_mask:0xf bank_mask:0xf
  ds_read_b128 v[24:27], v10 offset:6144
  s_waitcnt lgkmcnt(1)
  v_mfma_f32_16x16x16_bf16 v[12:15], v[22:23], v[36:37], v[12:15]
  v_mfma_f32_16x16x16_bf16 v[16:19], v[22:23], v[38:39], v[16:19]
  v_and_b32_dpp v20, v29, v3 quad_perm:[2,2,2,2] row_mask:0xf bank_mask:0xf
  v_and_b32_dpp v21, v29, v4 quad_perm:[2,2,2,2] row_mask:0xf bank_mask:0xf
  ds_read_b128 v[36:39], v10 offset:7168
  s_waitcnt lgkmcnt(1)
  v_mfma_f32_16x16x16_bf16 v[12:15], v[20:21], v[24:25], v[12:15]
  v_mfma_f32_16x16x16_bf16 v[16:19], v[20:21], v[26:27], v[16:19]
  v_and_b32_dpp v22, v29, v3 quad_perm:[3,3,3,3] row_mask:0xf bank_mask:0xf
  v_and_b32_dpp v23, v29, v4 quad_perm:[3,3,3,3] row_mask:0xf bank_mask:0xf
  ds_read_b128 v[24:27], v10 offset:8192
  s_waitcnt lgkmcnt(1)
  v_mfma_f32_16x16x16_bf16 v[12:15], v[22:23], v[36:37], v[12:15]
  v_mfma_f32_16x16x16_bf16 v[16:19], v[22:23], v[38:39], v[16:19]
  v_and_b32_dpp v20, v30, v3 quad_perm:[0,0,0,0] row_mask:0xf bank_mask:0xf
  v_and_b32_dpp v21, v30, v4 quad_perm:[0,0,0,0] row_mask:0xf bank_mask:0xf
  ds_read_b128 v[36:39], v10 offset:9216
  s_waitcnt lgkmcnt(1)
  v_mfma_f32_16x16x16_bf16 v[12:15], v[20:21], v[24:25], v[12:15]
  v_mfma_f32_16x16x16_bf16 v[16:19], v[20:21], v[26:27], v[16:19]
  v_and_b32_dpp v22, v30, v3 quad_perm:[1,1,1,1] row_mask:0xf bank_mask:0xf
  v_and_b32_dpp v23, v30, v4 quad_perm:[1,1,1,1] row_mask:0xf bank_mask:0xf
  s_waitcnt lgkmcnt(0)
  s_nop 0
  v_mfma_f32_16x16x16_bf16 v[12:15], v[22:23], v[36:37], v[12:15]
  v_mfma_f32_16x16x16_bf16 v[16:19], v[22:23], v[38:39], v[16:19]
  v_and_b32_dpp v20, v30, v3 quad_perm:[2,2,2,2] row_mask:0xf bank_mask:0xf
  v_and_b32_dpp v21, v30, v4 quad_perm:[2,2,2,2] row_mask:0xf bank_mask:0xf
  s_waitcnt vmcnt(3)
  buffer_load_dwordx4 v[56:59], v2, s[52:55], s61 offen nt
  s_add_u32 s61, s61, 8192
  v_mfma_f32_16x16x16_bf16 v[12:15], v[20:21], v[40:41], v[12:15]
  v_mfma_f32_16x16x16_bf16 v[16:19], v[20:21], v[42:43], v[16:19]
  v_and_b32_dpp v22, v30, v3 quad_perm:[3,3,3,3] row_mask:0xf bank_mask:0xf
  v_and_b32_dpp v23, v30, v4 quad_perm:[3,3,3,3] row_mask:0xf bank_mask:0xf
  s_waitcnt vmcnt(3)
  buffer_load_dwordx4 v[60:63], v2, s[52:55], s61 offen nt
  s_add_u32 s61, s61, 8192
  v_mfma_f32_16x16x16_bf16 v[12:15], v[22:23], v[44:45], v[12:15]
  v_mfma_f32_16x16x16_bf16 v[16:19], v[22:23], v[46:47], v[16:19]
  v_and_b32_dpp v20, v31, v3 quad_perm:[0,0,0,0] row_mask:0xf bank_mask:0xf
  v_and_b32_dpp v21, v31, v4 quad_perm:[0,0,0,0] row_mask:0xf bank_mask:0xf
  s_waitcnt vmcnt(3)
  buffer_load_dwordx4 v[64:67], v2, s[52:55], s61 offen nt
  s_add_u32 s61, s61, 8192
  v_mfma_f32_16x16x16_bf16 v[12:15], v[20:21], v[48:49], v[12:15]
  v_mfma_f32_16x16x16_bf16 v[16:19], v[20:21], v[50:51], v[16:19]
  v_and_b32_dpp v22, v31, v3 quad_perm:[1,1,1,1] row_mask:0xf bank_mask:0xf
  v_and_b32_dpp v23, v31, v4 quad_perm:[1,1,1,1] row_mask:0xf bank_mask:0xf
  s_waitcnt vmcnt(3)
  buffer_load_dwordx4 v[68:71], v2, s[52:55], s61 offen nt
  s_add_u32 s61, s61, 8192
  v_mfma_f32_16x16x16_bf16 v[12:15], v[22:23], v[52:53], v[12:15]
  v_mfma_f32_16x16x16_bf16 v[16:19], v[22:23], v[54:55], v[16:19]
  v_and_b32_dpp v20, v31, v3 quad_perm:[2,2,2,2] row_mask:0xf bank_mask:0xf
  v_and_b32_dpp v21, v31, v4 quad_perm:[2,2,2,2] row_mask:0xf bank_mask:0xf
  s_waitcnt vmcnt(3)
  buffer_load_dwordx4 v[72:75], v2, s[52:55], s61 offen nt
  s_add_u32 s61, s61, 8192
  v_mfma_f32_16x16x16_bf16 v[12:15], v[20:21], v[56:57], v[12:15]
  v_mfma_f32_16x16x16_bf16 v[16:19], v[20:21], v[58:59], v[16:19]
  v_and_b32_dpp v22, v31, v3 quad_perm:[3,3,3,3] row_mask:0xf bank_mask:0xf
  v_and_b32_dpp v23, v31, v4 quad_perm:[3,3,3,3] row_mask:0xf bank_mask:0xf
  s_waitcnt vmcnt(3)
  buffer_load_dwordx4 v[76:79], v2, s[52:55], s61 offen nt
  s_add_u32 s61, s61, 8192
  v_mfma_f32_16x16x16_bf16 v[12:15], v[22:23], v[60:61], v[12:15]
  v_mfma_f32_16x16x16_bf16 v[16:19], v[22:23], v[62:63], v[16:19]
  v_and_b32_dpp v20, v32, v3 quad_perm:[0,0,0,0] row_mask:0xf bank_mask:0xf
  v_and_b32_dpp v21, v32, v4 quad_perm:[0,0,0,0] row_mask:0xf bank_mask:0xf
  s_waitcnt vmcnt(3)
  buffer_load_dwordx4 v[80:83], v2, s[52:55], s61 offen nt
  s_add_u32 s61, s61, 8192
  v_mfma_f32_16x16x16_bf16 v[12:15], v[20:21], v[64:65], v[12:15]
  v_mfma_f32_16x16x16_bf16 v[16:19], v[20:21], v[66:67], v[16:19]
  v_and_b32_dpp v22, v32, v3 quad_perm:[1,1,1,1] row_mask:0xf bank_mask:0xf
  v_and_b32_dpp v23, v32, v4 quad_perm:[1,1,1,1] row_mask:0xf bank_mask:0xf
  s_waitcnt vmcnt(3)
  buffer_load_dwordx4 v[84:87], v2, s[52:55], s61 offen nt
  s_add_u32 s61, s61, 8192
  v_mfma_f32_16x16x16_bf16 v[12:15], v[22:23], v[68:69], v[12:15]
  v_mfma_f32_16x16x16_bf16 v[16:19], v[22:23], v[70:71], v[16:19]
  v_and_b32_dpp v20, v32, v3 quad_perm:[2,2,2,2] row_mask:0xf bank_mask:0xf
  v_and_b32_dpp v21, v32, v4 quad_perm:[2,2,2,2] row_mask:0xf bank_mask:0xf
  s_waitcnt vmcnt(3)
  buffer_load_dwordx4 v[88:91], v2, s[52:55], s61 offen nt
  s_add_u32 s61, s61, 8192
  v_mfma_f32_16x16x16_bf16 v[12:15], v[20:21], v[72:73], v[12:15]
  v_mfma_f32_16x16x16_bf16 v[16:19], v[20:21], v[74:75], v[16:19]
  v_and_b32_dpp v22, v32, v3 quad_perm:[3,3,3,3] row_mask:0xf bank_mask:0xf
  v_and_b32_dpp v23, v32, v4 quad_perm:[3,3,3,3] row_mask:0xf bank_mask:0xf
  s_waitcnt vmcnt(3)
  buffer_load_dwordx4 v[92:95], v2, s[52:55], s61 offen nt
  s_add_u32 s61, s61, 8192
  v_mfma_f32_16x16x16_bf16 v[12:15], v[22:23], v[76:77], v[12:15]
  v_mfma_f32_16x16x16_bf16 v[16:19], v[22:23], v[78:79], v[16:19]
  v_and_b32_dpp v20, v33, v3 quad_perm:[0,0,0,0] row_mask:0xf bank_mask:0xf
  v_and_b32_dpp v21, v33, v4 quad_perm:[0,0,0,0] row_mask:0xf bank_mask:0xf
  s_waitcnt vmcnt(3)
  buffer_load_dwordx4 v[96:99], v2, s[52:55], s61 offen nt
  s_add_u32 s61, s61, 8192
  v_mfma_f32_16x16x16_bf16 v[12:15], v[20:21], v[80:81], v[12:15]
  v_mfma_f32_16x16x16_bf16 v[16:19], v[20:21], v[82:83], v[16:19]
  v_and_b32_dpp v22, v33, v3 quad_perm:[1,1,1,1] row_mask:0xf bank_mask:0xf
  v_and_b32_dpp v23, v33, v4 quad_perm:[1,1,1,1] row_mask:0xf bank_mask:0xf
  s_waitcnt vmcnt(3)
  buffer_load_dwordx4 v[100:103], v2, s[52:55], s61 offen nt
  s_add_u32 s61, s61, 8192
  v_mfma_f32_16x16x16_bf16 v[12:15], v[22:23], v[84:85], v[12:15]
  v_mfma_f32_16x16x16_bf16 v[16:19], v[22:23], v[86:87], v[16:19]
L_cm_8:
  ds_read_b32 v161, v162
  s_waitcnt lgkmcnt(0)
  v_readfirstlane_b32 s62, v161
  s_add_u32 s80, s80, 1
  s_cmp_gt_u32 s80, 400000
  s_cbranch_scc1 L_abort
  s_cmp_lt_u32 s62, 8
  s_cbranch_scc1 L_cm_8
  ds_read_b32 v160, v155
  ds_read_b32 v161, v156
  ds_read_b32 v164, v154
  s_waitcnt lgkmcnt(0)
  v_sub_f32 v160, v160, v161
  v_sub_f32 v164, v8, v164
  v_exp_f32 v160, v160
  v_exp_f32 v164, v164
  s_nop 0
  v_mul_f32 v164, v9, v164
  s_mov_b64 exec, s[68:69]
  ds_add_f32 v154, v164 offset:16
  s_mov_b64 exec, -1
  v_and_b32_dpp v20, v33, v3 quad_perm:[2,2,2,2] row_mask:0xf bank_mask:0xf
  v_and_b32_dpp v21, v33, v4 quad_perm:[2,2,2,2] row_mask:0xf bank_mask:0xf
  s_waitcnt vmcnt(3)
  buffer_load_dwordx4 v[104:107], v2, s[52:55], s61 offen nt
  s_add_u32 s61, s61, 8192
  v_mfma_f32_16x16x16_bf16 v[12:15], v[20:21], v[88:89], v[12:15]
  v_mfma_f32_16x16x16_bf16 v[16:19], v[20:21], v[90:91], v[16:19]
  v_and_b32_dpp v22, v33, v3 quad_perm:[3,3,3,3] row_mask:0xf bank_mask:0xf
  v_and_b32_dpp v23, v33, v4 quad_perm:[3,3,3,3] row_mask:0xf bank_mask:0xf
  s_waitcnt vmcnt(3)
  buffer_load_dwordx4 v[108:111], v2, s[52:55], s61 offen nt
  v_mfma_f32_16x16x16_bf16 v[12:15], v[22:23], v[92:93], v[12:15]
  v_mfma_f32_16x16x16_bf16 v[16:19], v[22:23], v[94:95], v[16:19]
  v_and_b32_dpp v20, v34, v3 quad_perm:[0,0,0,0] row_mask:0xf bank_mask:0xf
  v_and_b32_dpp v21, v34, v4 quad_perm:[0,0,0,0] row_mask:0xf bank_mask:0xf
  s_waitcnt vmcnt(3)
  s_nop 0
  v_mfma_f32_16x16x16_bf16 v[12:15], v[20:21], v[96:97], v[12:15]
  v_mfma_f32_16x16x16_bf16 v[16:19], v[20:21], v[98:99], v[16:19]
  v_and_b32_dpp v22, v34, v3 quad_perm:[1,1,1,1] row_mask:0xf bank_mask:0xf
  v_and_b32_dpp v23, v34, v4 quad_perm:[1,1,1,1] row_mask:0xf bank_mask:0xf
  s_waitcnt vmcnt(2)
  s_nop 0
  v_mfma_f32_16x16x16_bf16 v[12:15], v[22:23], v[100:101], v[12:15]
  v_mfma_f32_16x16x16_bf16 v[16:19], v[22:23], v[102:103], v[16:19]
  v_and_b32_dpp v20, v34, v3 quad_perm:[2,2,2,2] row_mask:0xf bank_mask:0xf
  v_and_b32_dpp v21, v34, v4 quad_perm:[2,2,2,2] row_mask:0xf bank_mask:0xf
  s_waitcnt vmcnt(1)
  s_nop 0
  v_mfma_f32_16x16x16_bf16 v[12:15], v[20:21], v[104:105], v[12:15]
  v_mfma_f32_16x16x16_bf16 v[16:19], v[20:21], v[106:107], v[16:19]
  v_and_b32_dpp v22, v34, v3 quad_perm:[3,3,3,3] row_mask:0xf bank_mask:0xf
  v_and_b32_dpp v23, v34, v4 quad_perm:[3,3,3,3] row_mask:0xf bank_mask:0xf
  s_waitcnt vmcnt(0)
  s_nop 0
  v_mfma_f32_16x16x16_bf16 v[12:15], v[22:23], v[108:109], v[12:15]
  v_mfma_f32_16x16x16_bf16 v[16:19], v[22:23], v[110:111], v[16:19]
  s_branch L_att_done
L_att_34_2_0_0_0:
  s_lshl_b32 s60, s36, 23
  s_lshl_b32 s61, s62, 13
  s_add_u32 s60, s60, s61
  s_lshl_b32 s61, s3, 10
  s_add_u32 s60, s60, s61
  s_mov_b32 s61, s60
  s_barrier
  buffer_load_dwordx4 v[40:43], v1, s[48:51], s60 offen nt
  s_add_u32 s60, s60, 8192
  buffer_load_dwordx4 v[44:47], v1, s[48:51], s60 offen nt
  s_add_u32 s60, s60, 8192
  buffer_load_dwordx4 v[48:51], v1, s[48:51], s60 offen nt
  s_add_u32 s60, s60, 8192
  s_waitcnt vmcnt(2)
  buffer_load_dwordx4 v[52:55], v1, s[48:51], s60 offen nt
  s_add_u32 s60, s60, 8192
  s_waitcnt vmcnt(2)
  buffer_load_dwordx4 v[56:59], v1, s[48:51], s60 offen nt
  s_add_u32 s60, s60, 8192
  s_waitcnt vmcnt(2)
  buffer_load_dwordx4 v[60:63], v1, s[48:51], s60 offen nt
  s_add_u32 s60, s60, 8192
  s_waitcnt vmcnt(2)
  buffer_load_dwordx4 v[64:67], v1, s[48:51], s60 offen nt
  s_add_u32 s60, s60, 8192
  s_waitcnt vmcnt(2)
  buffer_load_dwordx4 v[68:71], v1, s[48:51], s60 offen nt
  s_add_u32 s60, s60, 8192
  s_waitcnt vmcnt(2)
  buffer_load_dwordx4 v[72:75], v1, s[48:51], s60 offen nt
  s_add_u32 s60, s60, 8192
  s_waitcnt vmcnt(2)
  buffer_load_dwordx4 v[76:79], v1, s[48:51], s60 offen nt
  s_add_u32 s60, s60, 8192
  s_waitcnt vmcnt(2)
  buffer_load_dwordx4 v[80:83], v1, s[48:51], s60 offen nt
  s_add_u32 s60, s60, 8192
  s_waitcnt vmcnt(2)
  buffer_load_dwordx4 v[84:87], v1, s[48:51], s60 offen nt
  s_add_u32 s60, s60, 8192
  s_waitcnt vmcnt(2)
  buffer_load_dwordx4 v[88:91], v1, s[48:51], s60 offen nt
  s_add_u32 s60, s60, 8192
  s_waitcnt vmcnt(2)
  buffer_load_dwordx4 v[92:95], v1, s[48:51], s60 offen nt
  s_add_u32 s60, s60, 8192
  s_waitcnt vmcnt(2)
  buffer_load_dwordx4 v[96:99], v1, s[48:51], s60 offen nt
  s_add_u32 s60, s60, 8192
  s_waitcnt vmcnt(2)
  buffer_load_dwordx4 v[100:103], v1, s[48:51], s60 offen nt
  s_add_u32 s60, s60, 8192
  s_waitcnt vmcnt(2)
  buffer_load_dwordx4 v[104:107], v1, s[48:51], s60 offen nt
  s_add_u32 s60, s60, 8192
  s_waitcnt vmcnt(2)
  buffer_load_dwordx4 v[108:111], v1, s[48:51], s60 offen nt
  s_add_u32 s60, s60, 8192
  s_waitcnt vmcnt(2)
  buffer_load_dwordx4 v[112:115], v1, s[48:51], s60 offen nt
  s_add_u32 s60, s60, 8192
  s_waitcnt vmcnt(2)
  buffer_load_dwordx4 v[116:119], v1, s[48:51], s60 offen nt
  s_add_u32 s60, s60, 8192
  s_waitcnt vmcnt(2)
  buffer_load_dwordx4 v[120:123], v1, s[48:51], s60 offen nt
  s_add_u32 s60, s60, 8192
  s_waitcnt vmcnt(2)
  buffer_load_dwordx4 v[124:127], v1, s[48:51], s60 offen nt
  s_add_u32 s60, s60, 8192
  s_waitcnt vmcnt(2)
  buffer_load_dwordx4 v[128:131], v1, s[48:51], s60 offen nt
  s_add_u32 s60, s60, 8192
  s_waitcnt vmcnt(2)
  buffer_load_dwordx4 v[132:135], v1, s[48:51], s60 offen nt
  s_add_u32 s60, s60, 8192
  s_waitcnt vmcnt(2)
  buffer_load_dwordx4 v[136:139], v1, s[48:51], s60 offen nt
  s_add_u32 s60, s60, 8192
  s_waitcnt vmcnt(2)
  buffer_load_dwordx4 v[140:143], v1, s[48:51], s60 offen nt
  s_add_u32 s60, s60, 8192
  s_waitcnt vmcnt(2)
  buffer_load_dwordx4 v[144:147], v1, s[48:51], s60 offen nt
  s_add_u32 s60, s60, 8192
  s_waitcnt vmcnt(2)
  buffer_load_dwordx4 v[148:151], v1, s[48:51], s60 offen nt
  s_add_u32 s60, s60, 8192
  s_waitcnt vmcnt(2)
  buffer_load_dwordx4 v[152:155], v1, s[48:51], s60 offen nt
  s_add_u32 s60, s60, 8192
  s_waitcnt vmcnt(2)
  buffer_load_dwordx4 v[156:159], v1, s[48:51], s60 offen nt
  s_add_u32 s60, s60, 8192
  s_waitcnt vmcnt(2)
  buffer_load_dwordx4 v[160:163], v1, s[48:51], s60 offen nt
  s_add_u32 s60, s60, 8192
  s_waitcnt vmcnt(2)
  buffer_load_dwordx4 v[164:167], v1, s[48:51], s60 offen nt
  s_add_u32 s60, s60, 8192
  s_waitcnt vmcnt(2)
  s_add_u32 m0, s63, 0
  s_nop 0
  buffer_load_dwordx4 v1, s[48:51], s60 offen nt lds
  s_add_u32 s60, s60, 8192
  s_waitcnt vmcnt(2)
  s_add_u32 m0, s63, 1024
  s_nop 0
  buffer_load_dwordx4 v1, s[48:51], s60 offen nt lds
  s_waitcnt vmcnt(2)
  s_add_u32 m0, s63, 2048
  s_nop 0
  buffer_load_dwordx4 v2, s[52:55], s61 offen nt lds
  s_add_u32 s61, s61, 8192
  s_waitcnt vmcnt(2)
  s_add_u32 m0, s63, 3072
  s_nop 0
  buffer_load_dwordx4 v2, s[52:55], s61 offen nt lds
  s_add_u32 s61, s61, 8192
  s_waitcnt vmcnt(2)
  s_add_u32 m0, s63, 4096
  s_nop 0
  buffer_load_dwordx4 v2, s[52:55], s61 offen nt lds
  s_add_u32 s61, s61, 8192
  s_waitcnt vmcnt(2)
  s_add_u32 m0, s63, 5120
  s_nop 0
  buffer_load_dwordx4 v2, s[52:55], s61 offen nt lds
  s_add_u32 s61, s61, 8192
  s_waitcnt vmcnt(2)
  s_add_u32 m0, s63, 6144
  s_nop 0
  buffer_load_dwordx4 v2, s[52:55], s61 offen nt lds
  s_add_u32 s61, s61, 8192
  s_waitcnt vmcnt(2)
  s_add_u32 m0, s63, 7168
  s_nop 0
  buffer_load_dwordx4 v2, s[52:55], s61 offen nt lds
  s_add_u32 s61, s61, 8192
  s_waitcnt vmcnt(2)
  s_add_u32 m0, s63, 8192
  s_nop 0
  buffer_load_dwordx4 v2, s[52:55], s61 offen nt lds
  s_add_u32 s61, s61, 8192
  s_waitcnt vmcnt(2)
  s_add_u32 m0, s63, 9216
  s_nop 0
  buffer_load_dwordx4 v2, s[52:55], s61 offen nt lds
  s_add_u32 s61, s61, 8192
  s_waitcnt vmcnt(2)
  s_barrier
  ds_read_b128 v[8:11], v6
  v_mov_b32 v12, 153064
  ds_read_b32 v13, v12
  v_add_u32 v6, s63, v2
  s_waitcnt lgkmcnt(0)
  v_readfirstlane_b32 s75, v13
  v_mfma_f32_16x16x32_bf16 v[12:15], v[40:43], v[8:11], 0
  v_mfma_f32_16x16x32_bf16 v[16:19], v[44:47], v[8:11], 0
  v_mfma_f32_16x16x32_bf16 v[20:23], v[48:51], v[8:11], 0
  v_mfma_f32_16x16x32_bf16 v[24:27], v[52:55], v[8:11], 0
  buffer_load_dwordx4 v[40:43], v2, s[52:55], s61 offen nt
  s_add_u32 s61, s61, 8192
  buffer_load_dwordx4 v[44:47], v2, s[52:55], s61 offen nt
  s_add_u32 s61, s61, 8192
  buffer_load_dwordx4 v[48:51], v2, s[52:55], s61 offen nt
  s_add_u32 s61, s61, 8192
  v_cndmask_b32 v36, v12, v17, s[56:57]
  s_nop 0
  v_cndmask_b32 v37, v22, v27, s[56:57]
  v_cndmask_b32 v28, v36, v37, s[58:59]
  v_cndmask_b32 v36, v16, v13, s[56:57]
  v_cndmask_b32 v37, v26, v23, s[56:57]
  v_cndmask_b32 v39, v36, v37, s[58:59]
  s_nop 1
  v_add_f32_dpp v28, v39, v28 quad_perm:[1,0,3,2] row_mask:0xf bank_mask:0xf
  v_cndmask_b32 v36, v20, v25, s[56:57]
  v_cndmask_b32 v37, v14, v19, s[56:57]
  v_cndmask_b32 v38, v36, v37, s[58:59]
  s_nop 1
  v_add_f32_dpp v28, v38, v28 quad_perm:[2,3,0,1] row_mask:0xf bank_mask:0xf
  v_cndmask_b32 v36, v24, v21, s[56:57]
  v_cndmask_b32 v37, v18, v15, s[56:57]
  v_cndmask_b32 v39, v36, v37, s[58:59]
  s_nop 1
  v_add_f32_dpp v28, v39, v28 quad_perm:[3,2,1,0] row_mask:0xf bank_mask:0xf
  v_mfma_f32_16x16x32_bf16 v[12:15], v[56:59], v[8:11], 0
  v_mfma_f32_16x16x32_bf16 v[16:19], v[60:63], v[8:11], 0
  v_mfma_f32_16x16x32_bf16 v[20:23], v[64:67], v[8:11], 0
  v_mfma_f32_16x16x32_bf16 v[24:27], v[68:71], v[8:11], 0
  s_nop 5
  v_cndmask_b32 v36, v12, v17, s[56:57]
  s_nop 0
  v_cndmask_b32 v37, v22, v27, s[56:57]
  v_cndmask_b32 v29, v36, v37, s[58:59]
  v_cndmask_b32 v36, v16, v13, s[56:57]
  v_cndmask_b32 v37, v26, v23, s[56:57]
  v_cndmask_b32 v39, v36, v37, s[58:59]
  s_nop 1
  v_add_f32_dpp v29, v39, v29 quad_perm:[1,0,3,2] row_mask:0xf bank_mask:0xf
  v_cndmask_b32 v36, v20, v25, s[56:57]
  v_cndmask_b32 v37, v14, v19, s[56:57]
  v_cndmask_b32 v38, v36, v37, s[58:59]
  s_nop 1
  v_add_f32_dpp v29, v38, v29 quad_perm:[2,3,0,1] row_mask:0xf bank_mask:0xf
  v_cndmask_b32 v36, v24, v21, s[56:57]
  v_cndmask_b32 v37, v18, v15, s[56:57]
  v_cndmask_b32 v39, v36, v37, s[58:59]
  s_nop 1
  v_add_f32_dpp v29, v39, v29 quad_perm:[3,2,1,0] row_mask:0xf bank_mask:0xf
  v_mfma_f32_16x16x32_bf16 v[12:15], v[72:75], v[8:11], 0
  v_mfma_f32_16x16x32_bf16 v[16:19], v[76:79], v[8:11], 0
  v_mfma_f32_16x16x32_bf16 v[20:23], v[80:83], v[8:11], 0
  v_mfma_f32_16x16x32_bf16 v[24:27], v[84:87], v[8:11], 0
  s_nop 5
  v_cndmask_b32 v36, v12, v17, s[56:57]
  s_nop 0
  v_cndmask_b32 v37, v22, v27, s[56:57]
  v_cndmask_b32 v30, v36, v37, s[58:59]
  v_cndmask_b32 v36, v16, v13, s[56:57]
  v_cndmask_b32 v37, v26, v23, s[56:57]
  v_cndmask_b32 v39, v36, v37, s[58:59]
  s_nop 1
  v_add_f32_dpp v30, v39, v30 quad_perm:[1,0,3,2] row_mask:0xf bank_mask:0xf
  v_cndmask_b32 v36, v20, v25, s[56:57]
  v_cndmask_b32 v37, v14, v19, s[56:57]
  v_cndmask_b32 v38, v36, v37, s[58:59]
  s_nop 1
  v_add_f32_dpp v30, v38, v30 quad_perm:[2,3,0,1] row_mask:0xf bank_mask:0xf
  v_cndmask_b32 v36, v24, v21, s[56:57]
  v_cndmask_b32 v37, v18, v15, s[56:57]
  v_cndmask_b32 v39, v36, v37, s[58:59]
  s_nop 1
  v_add_f32_dpp v30, v39, v30 quad_perm:[3,2,1,0] row_mask:0xf bank_mask:0xf
  v_mfma_f32_16x16x32_bf16 v[12:15], v[88:91], v[8:11], 0
  v_mfma_f32_16x16x32_bf16 v[16:19], v[92:95], v[8:11], 0
  v_mfma_f32_16x16x32_bf16 v[20:23], v[96:99], v[8:11], 0
  v_mfma_f32_16x16x32_bf16 v[24:27], v[100:103], v[8:11], 0
  s_nop 5
  v_cndmask_b32 v36, v12, v17, s[56:57]
  s_nop 0
  v_cndmask_b32 v37, v22, v27, s[56:57]
  v_cndmask_b32 v31, v36, v37, s[58:59]
  v_cndmask_b32 v36, v16, v13, s[56:57]
  v_cndmask_b32 v37, v26, v23, s[56:57]
  v_cndmask_b32 v39, v36, v37, s[58:59]
  s_nop 1
  v_add_f32_dpp v31, v39, v31 quad_perm:[1,0,3,2] row_mask:0xf bank_mask:0xf
  v_cndmask_b32 v36, v20, v25, s[56:57]
  v_cndmask_b32 v37, v14, v19, s[56:57]
  v_cndmask_b32 v38, v36, v37, s[58:59]
  s_nop 1
  v_add_f32_dpp v31, v38, v31 quad_perm:[2,3,0,1] row_mask:0xf bank_mask:0xf
  v_cndmask_b32 v36, v24, v21, s[56:57]
  v_cndmask_b32 v37, v18, v15, s[56:57]
  v_cndmask_b32 v39, v36, v37, s[58:59]
  s_nop 1
  v_add_f32_dpp v31, v39, v31 quad_perm:[3,2,1,0] row_mask:0xf bank_mask:0xf
  v_mfma_f32_16x16x32_bf16 v[12:15], v[104:107], v[8:11], 0
  v_mfma_f32_16x16x32_bf16 v[16:19], v[108:111], v[8:11], 0
  v_mfma_f32_16x16x32_bf16 v[20:23], v[112:115], v[8:11], 0
  v_mfma_f32_16x16x32_bf16 v[24:27], v[116:119], v[8:11], 0
  buffer_load_dwordx4 v[52:55], v2, s[52:55], s61 offen nt
  s_add_u32 s61, s61, 8192
  s_nop 3
  v_cndmask_b32 v36, v12, v17, s[56:57]
  s_nop 0
  v_cndmask_b32 v37, v22, v27, s[56:57]
  v_cndmask_b32 v32, v36, v37, s[58:59]
  v_cndmask_b32 v36, v16, v13, s[56:57]
  v_cndmask_b32 v37, v26, v23, s[56:57]
  v_cndmask_b32 v39, v36, v37, s[58:59]
  s_nop 1
  v_add_f32_dpp v32, v39, v32 quad_perm:[1,0,3,2] row_mask:0xf bank_mask:0xf
  v_cndmask_b32 v36, v20, v25, s[56:57]
  v_cndmask_b32 v37, v14, v19, s[56:57]
  v_cndmask_b32 v38, v36, v37, s[58:59]
  s_nop 1
  v_add_f32_dpp v32, v38, v32 quad_perm:[2,3,0,1] row_mask:0xf bank_mask:0xf
  v_cndmask_b32 v36, v24, v21, s[56:57]
  v_cndmask_b32 v37, v18, v15, s[56:57]
  v_cndmask_b32 v39, v36, v37, s[58:59]
  s_nop 1
  v_add_f32_dpp v32, v39, v32 quad_perm:[3,2,1,0] row_mask:0xf bank_mask:0xf
  v_mfma_f32_16x16x32_bf16 v[12:15], v[120:123], v[8:11], 0
  v_mfma_f32_16x16x32_bf16 v[16:19], v[124:127], v[8:11], 0
  v_mfma_f32_16x16x32_bf16 v[20:23], v[128:131], v[8:11], 0
  v_mfma_f32_16x16x32_bf16 v[24:27], v[132:135], v[8:11], 0
  s_nop 5
  v_cndmask_b32 v36, v12, v17, s[56:57]
  s_nop 0
  v_cndmask_b32 v37, v22, v27, s[56:57]
  v_cndmask_b32 v33, v36, v37, s[58:59]
  v_cndmask_b32 v36, v16, v13, s[56:57]
  v_cndmask_b32 v37, v26, v23, s[56:57]
  v_cndmask_b32 v39, v36, v37, s[58:59]
  s_nop 1
  v_add_f32_dpp v33, v39, v33 quad_perm:[1,0,3,2] row_mask:0xf bank_mask:0xf
  v_cndmask_b32 v36, v20, v25, s[56:57]
  v_cndmask_b32 v37, v14, v19, s[56:57]
  v_cndmask_b32 v38, v36, v37, s[58:59]
  s_nop 1
  v_add_f32_dpp v33, v38, v33 quad_perm:[2,3,0,1] row_mask:0xf bank_mask:0xf
  v_cndmask_b32 v36, v24, v21, s[56:57]
  v_cndmask_b32 v37, v18, v15, s[56:57]
  v_cndmask_b32 v39, v36, v37, s[58:59]
  s_nop 1
  v_add_f32_dpp v33, v39, v33 quad_perm:[3,2,1,0] row_mask:0xf bank_mask:0xf
  v_mfma_f32_16x16x32_bf16 v[12:15], v[136:139], v[8:11], 0
  v_mfma_f32_16x16x32_bf16 v[16:19], v[140:143], v[8:11], 0
  v_mfma_f32_16x16x32_bf16 v[20:23], v[144:147], v[8:11], 0
  v_mfma_f32_16x16x32_bf16 v[24:27], v[148:151], v[8:11], 0
  s_nop 5
  v_cndmask_b32 v36, v12, v17, s[56:57]
  s_nop 0
  v_cndmask_b32 v37, v22, v27, s[56:57]
  v_cndmask_b32 v34, v36, v37, s[58:59]
  v_cndmask_b32 v36, v16, v13, s[56:57]
  v_cndmask_b32 v37, v26, v23, s[56:57]
  v_cndmask_b32 v39, v36, v37, s[58:59]
  s_nop 1
  v_add_f32_dpp v34, v39, v34 quad_perm:[1,0,3,2] row_mask:0xf bank_mask:0xf
  v_cndmask_b32 v36, v20, v25, s[56:57]
  v_cndmask_b32 v37, v14, v19, s[56:57]
  v_cndmask_b32 v38, v36, v37, s[58:59]
  s_nop 1
  v_add_f32_dpp v34, v38, v34 quad_perm:[2,3,0,1] row_mask:0xf bank_mask:0xf
  v_cndmask_b32 v36, v24, v21, s[56:57]
  v_cndmask_b32 v37, v18, v15, s[56:57]
  v_cndmask_b32 v39, v36, v37, s[58:59]
  s_nop 1
  v_add_f32_dpp v34, v39, v34 quad_perm:[3,2,1,0] row_mask:0xf bank_mask:0xf
  v_mfma_f32_16x16x32_bf16 v[12:15], v[152:155], v[8:11], 0
  v_mfma_f32_16x16x32_bf16 v[16:19], v[156:159], v[8:11], 0
  v_mfma_f32_16x16x32_bf16 v[20:23], v[160:163], v[8:11], 0
  v_mfma_f32_16x16x32_bf16 v[24:27], v[164:167], v[8:11], 0
  s_nop 5
  v_cndmask_b32 v36, v12, v17, s[56:57]
  s_nop 0
  v_cndmask_b32 v37, v22, v27, s[56:57]
  v_cndmask_b32 v35, v36, v37, s[58:59]
  v_cndmask_b32 v36, v16, v13, s[56:57]
  v_cndmask_b32 v37, v26, v23, s[56:57]
  v_cndmask_b32 v39, v36, v37, s[58:59]
  s_nop 1
  v_add_f32_dpp v35, v39, v35 quad_perm:[1,0,3,2] row_mask:0xf bank_mask:0xf
  v_cndmask_b32 v36, v20, v25, s[56:57]
  v_cndmask_b32 v37, v14, v19, s[56:57]
  v_cndmask_b32 v38, v36, v37, s[58:59]
  s_nop 1
  v_add_f32_dpp v35, v38, v35 quad_perm:[2,3,0,1] row_mask:0xf bank_mask:0xf
  v_cndmask_b32 v36, v24, v21, s[56:57]
  v_cndmask_b32 v37, v18, v15, s[56:57]
  v_cndmask_b32 v39, v36, v37, s[58:59]
  s_nop 1
  v_add_f32_dpp v35, v39, v35 quad_perm:[3,2,1,0] row_mask:0xf bank_mask:0xf
  ds_read_b128 v[152:155], v6 offset:0
  ds_read_b128 v[156:159], v6 offset:1024
  s_waitcnt lgkmcnt(0)
  v_mfma_f32_16x16x32_bf16 v[12:15], v[152:155], v[8:11], 0
  v_mfma_f32_16x16x32_bf16 v[16:19], v[156:159], v[8:11], 0
  s_nop 7
  v_cndmask_b32 v36, v12, v17, s[56:57]
  v_cndmask_b32 v37, v22, v27, s[56:57]
  v_cndmask_b32 v7, v36, v37, s[58:59]
  v_cndmask_b32 v36, v16, v13, s[56:57]
  v_cndmask_b32 v37, v26, v23, s[56:57]
  v_cndmask_b32 v39, v36, v37, s[58:59]
  s_nop 1
  v_add_f32_dpp v7, v39, v7 quad_perm:[1,0,3,2] row_mask:0xf bank_mask:0xf
  v_cndmask_b32 v36, v20, v25, s[56:57]
  v_cndmask_b32 v37, v14, v19, s[56:57]
  v_cndmask_b32 v38, v36, v37, s[58:59]
  s_nop 1
  v_add_f32_dpp v7, v38, v7 quad_perm:[2,3,0,1] row_mask:0xf bank_mask:0xf
  v_cndmask_b32 v36, v24, v21, s[56:57]
  v_cndmask_b32 v37, v18, v15, s[56:57]
  v_cndmask_b32 v39, v36, v37, s[58:59]
  s_nop 1
  v_add_f32_dpp v7, v39, v7 quad_perm:[3,2,1,0] row_mask:0xf bank_mask:0xf
  s_mov_b32 s64, 0xcccccccc
  s_mov_b32 s65, 0xcccccccc
  v_mov_b32 v36, 0xfe000000
  v_cndmask_b32 v7, v7, v36, s[64:65]
  v_cvt_pk_bf16_f32 v36, v28, v29
  v_lshlrev_b32 v28, 16, v36
  v_and_b32 v29, 0xffff0000, v36
  v_cvt_pk_bf16_f32 v37, v30, v31
  v_lshlrev_b32 v30, 16, v37
  v_and_b32 v31, 0xffff0000, v37
  v_cvt_pk_bf16_f32 v36, v32, v33
  v_lshlrev_b32 v32, 16, v36
  v_and_b32 v33, 0xffff0000, v36
  v_cvt_pk_bf16_f32 v37, v34, v35
  v_lshlrev_b32 v34, 16, v37
  v_and_b32 v35, 0xffff0000, v37
  v_cvt_pk_bf16_f32 v36, v7, v7
  v_lshlrev_b32 v7, 16, v36
  s_mov_b32 s62, 0x3db504f3
  v_mul_f32 v28, s62, v28
  v_mul_f32 v29, s62, v29
  v_mul_f32 v30, s62, v30
  v_mul_f32 v31, s62, v31
  v_mul_f32 v32, s62, v32
  v_mul_f32 v33, s62, v33
  v_mul_f32 v34, s62, v34
  v_mul_f32 v35, s62, v35
  v_mul_f32 v7, s62, v7
  v_cvt_pk_bf16_f32 v36, v28, v29
  v_lshlrev_b32 v28, 16, v36
  v_and_b32 v29, 0xffff0000, v36
  v_cvt_pk_bf16_f32 v37, v30, v31
  v_lshlrev_b32 v30, 16, v37
  v_and_b32 v31, 0xffff0000, v37
  v_cvt_pk_bf16_f32 v36, v32, v33
  v_lshlrev_b32 v32, 16, v36
  v_and_b32 v33, 0xffff0000, v36
  v_cvt_pk_bf16_f32 v37, v34, v35
  v_lshlrev_b32 v34, 16, v37
  v_and_b32 v35, 0xffff0000, v37
  v_cvt_pk_bf16_f32 v36, v7, v7
  v_lshlrev_b32 v7, 16, v36
  v_max_f32 v8, v28, v29
  v_max3_f32 v8, v8, v30, v31
  v_max3_f32 v8, v8, v32, v33
  v_max3_f32 v8, v8, v34, v35
  v_max_f32 v8, v8, v7
  s_nop 1
  v_max_f32_dpp v8, v8, v8 quad_perm:[1,0,3,2] row_mask:0xf bank_mask:0xf
  s_nop 1
  v_max_f32_dpp v8, v8, v8 quad_perm:[2,3,0,1] row_mask:0xf bank_mask:0xf
  v_mov_b32 v36, v8
  s_nop 1
  v_permlane16_swap_b32 v8, v36
  v_max_f32 v8, v8, v36
  v_mov_b32 v36, v8
  s_nop 1
  v_permlane32_swap_b32 v8, v36
  v_max_f32 v8, v8, v36
  s_mov_b32 s62, 0x3fb8aa3b
  v_mul_f32 v8, s62, v8
  v_fma_f32 v28, v28, s62, -v8
  v_fma_f32 v29, v29, s62, -v8
  v_fma_f32 v30, v30, s62, -v8
  v_fma_f32 v31, v31, s62, -v8
  v_fma_f32 v32, v32, s62, -v8
  v_fma_f32 v33, v33, s62, -v8
  v_fma_f32 v34, v34, s62, -v8
  v_fma_f32 v35, v35, s62, -v8
  v_fma_f32 v7, v7, s62, -v8
  v_exp_f32 v28, v28
  v_exp_f32 v29, v29
  v_exp_f32 v30, v30
  v_exp_f32 v31, v31
  v_exp_f32 v32, v32
  v_exp_f32 v33, v33
  v_exp_f32 v34, v34
  v_exp_f32 v35, v35
  v_exp_f32 v7, v7
  v_add_f32 v9, v28, v29
  v_add_f32 v9, v9, v30
  v_add_f32 v9, v9, v31
  v_add_f32 v9, v9, v32
  v_add_f32 v9, v9, v33
  v_add_f32 v9, v9, v34
  v_add_f32 v9, v9, v35
  v_add_f32 v9, v9, v7
  v_cvt_pk_bf16_f32 v28, v28, v28
  v_cvt_pk_bf16_f32 v29, v29, v29
  v_cvt_pk_bf16_f32 v30, v30, v30
  v_cvt_pk_bf16_f32 v31, v31, v31
  v_cvt_pk_bf16_f32 v32, v32, v32
  v_cvt_pk_bf16_f32 v33, v33, v33
  v_cvt_pk_bf16_f32 v34, v34, v34
  v_cvt_pk_bf16_f32 v35, v35, v35
  v_cvt_pk_bf16_f32 v7, v7, v7
  v_add_f32_dpp v9, v9, v9 quad_perm:[1,0,3,2] row_mask:0xf bank_mask:0xf
  s_nop 1
  v_add_f32_dpp v9, v9, v9 quad_perm:[2,3,0,1] row_mask:0xf bank_mask:0xf
  v_mov_b32 v36, v9
  s_nop 1
  v_permlane16_swap_b32 v9, v36
  v_add_f32 v9, v9, v36
  v_mov_b32 v36, v9
  s_nop 1
  v_permlane32_swap_b32 v9, v36
  v_add_f32 v9, v9, v36
  v_lshlrev_b32 v152, 5, v0
  v_add_u32 v152, s63, v152
  v_bfe_u32 v165, v0, 2, 2
  s_lshl_b32 s62, s3, 2
  s_add_u32 s62, s62, 147456
  v_lshlrev_b32 v153, 5, v165
  v_add_u32 v153, s62, v153
  v_lshlrev_b32 v154, 2, v165
  v_add_u32 v154, 153024, v154
  v_lshrrev_b32 v165, 4, v0
  v_lshlrev_b32 v155, 5, v165
  v_add_u32 v155, s62, v155
  v_lshlrev_b32 v156, 2, v165
  v_add_u32 v156, 153024, v156
  v_and_b32 v166, 0x33, v0
  v_cmp_eq_u32 s[68:69], 0, v166
  v_mov_b32 v162, 153056
  v_mov_b32 v163, 1
  s_mov_b64 exec, s[68:69]
  ds_write_b32 v153, v8
  ds_max_f32 v154, v8
  s_mov_b64 exec, 1
  ds_add_u32 v162, v163
  s_mov_b64 exec, -1
  v_and_b32 v166, 15, v0
  v_lshrrev_b32 v157, 2, v166
  v_lshlrev_b32 v157, 12, v157
  v_and_b32 v167, 3, v166
  v_lshl_add_u32 v157, v167, 5, v157
  v_and_b32 v164, 1, v165
  v_lshl_add_u32 v157, v164, 4, v157
  v_and_b32 v158, 1, v166
  v_lshlrev_b32 v158, 4, v158
  v_lshl_add_u32 v158, v164, 3, v158
  v_lshrrev_b32 v159, 2, v166
  v_lshl_add_u32 v158, v159, 6, v158
  v_lshrrev_b32 v159, 1, v167
  v_lshl_add_u32 v158, v159, 5, v158
  v_lshrrev_b32 v159, 5, v0
  s_mov_b32 s62, 40960
  v_mul_lo_u32 v159, v159, s62
  v_add_u32 v158, v158, v159
  s_lshr_b32 s62, s3, 1
  s_lshl_b32 s62, s62, 9
  s_and_b32 s64, s3, 1
  s_lshl_b32 s64, s64, 8
  s_add_u32 s62, s62, s64
  s_add_u32 s62, s62, 65536
  v_add_u32 v158, s62, v158
  s_lshr_b32 s62, s3, 1
  s_lshl_b32 s62, s62, 2
  s_add_u32 s62, s62, 153024
  v_mov_b32 v159, s62
  s_lshl_b32 s66, s36, 5
  s_lshl_b32 s62, s3, 2
  s_add_u32 s66, s66, s62
  s_lshl_b32 s66, s66, 5
  s_add_u32 s66, s66, s37
  s_lshl_b32 s66, s66, 7
  s_add_u32 s67, s66, 5242880
  v_add_u32 v10, s63, v2
  s_waitcnt vmcnt(5)
  s_waitcnt vmcnt(4)
  ds_read_b128 v[24:27], v10 offset:2048
  v_and_b32_dpp v20, v28, v3 quad_perm:[0,0,0,0] row_mask:0xf bank_mask:0xf
  v_and_b32_dpp v21, v28, v4 quad_perm:[0,0,0,0] row_mask:0xf bank_mask:0xf
  ds_read_b128 v[36:39], v10 offset:3072
  s_waitcnt lgkmcnt(1)
  v_mfma_f32_16x16x16_bf16 v[12:15], v[20:21], v[24:25], 0
  v_mfma_f32_16x16x16_bf16 v[16:19], v[20:21], v[26:27], 0
  v_and_b32_dpp v22, v28, v3 quad_perm:[1,1,1,1] row_mask:0xf bank_mask:0xf
  v_and_b32_dpp v23, v28, v4 quad_perm:[1,1,1,1] row_mask:0xf bank_mask:0xf
  ds_read_b128 v[24:27], v10 offset:4096
  s_waitcnt lgkmcnt(1)
  v_mfma_f32_16x16x16_bf16 v[12:15], v[22:23], v[36:37], v[12:15]
  v_mfma_f32_16x16x16_bf16 v[16:19], v[22:23], v[38:39], v[16:19]
  v_and_b32_dpp v20, v28, v3 quad_perm:[2,2,2,2] row_mask:0xf bank_mask:0xf
  v_and_b32_dpp v21, v28, v4 quad_perm:[2,2,2,2] row_mask:0xf bank_mask:0xf
  ds_read_b128 v[36:39], v10 offset:5120
  s_waitcnt lgkmcnt(1)
  v_mfma_f32_16x16x16_bf16 v[12:15], v[20:21], v[24:25], v[12:15]
  v_mfma_f32_16x16x16_bf16 v[16:19], v[20:21], v[26:27], v[16:19]
  v_and_b32_dpp v22, v28, v3 quad_perm:[3,3,3,3] row_mask:0xf bank_mask:0xf
  v_and_b32_dpp v23, v28, v4 quad_perm:[3,3,3,3] row_mask:0xf bank_mask:0xf
  ds_read_b128 v[24:27], v10 offset:6144
  s_waitcnt lgkmcnt(1)
  v_mfma_f32_16x16x16_bf16 v[12:15], v[22:23], v[36:37], v[12:15]
  v_mfma_f32_16x16x16_bf16 v[16:19], v[22:23], v[38:39], v[16:19]
  v_and_b32_dpp v20, v29, v3 quad_perm:[0,0,0,0] row_mask:0xf bank_mask:0xf
  v_and_b32_dpp v21, v29, v4 quad_perm:[0,0,0,0] row_mask:0xf bank_mask:0xf
  ds_read_b128 v[36:39], v10 offset:7168
  s_waitcnt lgkmcnt(1)
  v_mfma_f32_16x16x16_bf16 v[12:15], v[20:21], v[24:25], v[12:15]
  v_mfma_f32_16x16x16_bf16 v[16:19], v[20:21], v[26:27], v[16:19]
  v_and_b32_dpp v22, v29, v3 quad_perm:[1,1,1,1] row_mask:0xf bank_mask:0xf
  v_and_b32_dpp v23, v29, v4 quad_perm:[1,1,1,1] row_mask:0xf bank_mask:0xf
  ds_read_b128 v[24:27], v10 offset:8192
  s_waitcnt lgkmcnt(1)
  v_mfma_f32_16x16x16_bf16 v[12:15], v[22:23], v[36:37], v[12:15]
  v_mfma_f32_16x16x16_bf16 v[16:19], v[22:23], v[38:39], v[16:19]
  v_and_b32_dpp v20, v29, v3 quad_perm:[2,2,2,2] row_mask:0xf bank_mask:0xf
  v_and_b32_dpp v21, v29, v4 quad_perm:[2,2,2,2] row_mask:0xf bank_mask:0xf
  ds_read_b128 v[36:39], v10 offset:9216
  s_waitcnt lgkmcnt(1)
  v_mfma_f32_16x16x16_bf16 v[12:15], v[20:21], v[24:25], v[12:15]
  v_mfma_f32_16x16x16_bf16 v[16:19], v[20:21], v[26:27], v[16:19]
  v_and_b32_dpp v22, v29, v3 quad_perm:[3,3,3,3] row_mask:0xf bank_mask:0xf
  v_and_b32_dpp v23, v29, v4 quad_perm:[3,3,3,3] row_mask:0xf bank_mask:0xf
  s_waitcnt lgkmcnt(0)
  s_nop 0
  v_mfma_f32_16x16x16_bf16 v[12:15], v[22:23], v[36:37], v[12:15]
  v_mfma_f32_16x16x16_bf16 v[16:19], v[22:23], v[38:39], v[16:19]
  v_and_b32_dpp v20, v30, v3 quad_perm:[0,0,0,0] row_mask:0xf bank_mask:0xf
  v_and_b32_dpp v21, v30, v4 quad_perm:[0,0,0,0] row_mask:0xf bank_mask:0xf
  s_waitcnt vmcnt(3)
  buffer_load_dwordx4 v[56:59], v2, s[52:55], s61 offen nt
  s_add_u32 s61, s61, 8192
  v_mfma_f32_16x16x16_bf16 v[12:15], v[20:21], v[40:41], v[12:15]
  v_mfma_f32_16x16x16_bf16 v[16:19], v[20:21], v[42:43], v[16:19]
  v_and_b32_dpp v22, v30, v3 quad_perm:[1,1,1,1] row_mask:0xf bank_mask:0xf
  v_and_b32_dpp v23, v30, v4 quad_perm:[1,1,1,1] row_mask:0xf bank_mask:0xf
  s_waitcnt vmcnt(3)
  buffer_load_dwordx4 v[60:63], v2, s[52:55], s61 offen nt
  s_add_u32 s61, s61, 8192
  v_mfma_f32_16x16x16_bf16 v[12:15], v[22:23], v[44:45], v[12:15]
  v_mfma_f32_16x16x16_bf16 v[16:19], v[22:23], v[46:47], v[16:19]
  v_and_b32_dpp v20, v30, v3 quad_perm:[2,2,2,2] row_mask:0xf bank_mask:0xf
  v_and_b32_dpp v21, v30, v4 quad_perm:[2,2,2,2] row_mask:0xf bank_mask:0xf
  s_waitcnt vmcnt(3)
  buffer_load_dwordx4 v[64:67], v2, s[52:55], s61 offen nt
  s_add_u32 s61, s61, 8192
  v_mfma_f32_16x16x16_bf16 v[12:15], v[20:21], v[48:49], v[12:15]
  v_mfma_f32_16x16x16_bf16 v[16:19], v[20:21], v[50:51], v[16:19]
  v_and_b32_dpp v22, v30, v3 quad_perm:[3,3,3,3] row_mask:0xf bank_mask:0xf
  v_and_b32_dpp v23, v30, v4 quad_perm:[3,3,3,3] row_mask:0xf bank_mask:0xf
  s_waitcnt vmcnt(3)
  buffer_load_dwordx4 v[68:71], v2, s[52:55], s61 offen nt
  s_add_u32 s61, s61, 8192
  v_mfma_f32_16x16x16_bf16 v[12:15], v[22:23], v[52:53], v[12:15]
  v_mfma_f32_16x16x16_bf16 v[16:19], v[22:23], v[54:55], v[16:19]
  v_and_b32_dpp v20, v31, v3 quad_perm:[0,0,0,0] row_mask:0xf bank_mask:0xf
  v_and_b32_dpp v21, v31, v4 quad_perm:[0,0,0,0] row_mask:0xf bank_mask:0xf
  s_waitcnt vmcnt(3)
  buffer_load_dwordx4 v[72:75], v2, s[52:55], s61 offen nt
  s_add_u32 s61, s61, 8192
  v_mfma_f32_16x16x16_bf16 v[12:15], v[20:21], v[56:57], v[12:15]
  v_mfma_f32_16x16x16_bf16 v[16:19], v[20:21], v[58:59], v[16:19]
  v_and_b32_dpp v22, v31, v3 quad_perm:[1,1,1,1] row_mask:0xf bank_mask:0xf
  v_and_b32_dpp v23, v31, v4 quad_perm:[1,1,1,1] row_mask:0xf bank_mask:0xf
  s_waitcnt vmcnt(3)
  buffer_load_dwordx4 v[76:79], v2, s[52:55], s61 offen nt
  s_add_u32 s61, s61, 8192
  v_mfma_f32_16x16x16_bf16 v[12:15], v[22:23], v[60:61], v[12:15]
  v_mfma_f32_16x16x16_bf16 v[16:19], v[22:23], v[62:63], v[16:19]
  v_and_b32_dpp v20, v31, v3 quad_perm:[2,2,2,2] row_mask:0xf bank_mask:0xf
  v_and_b32_dpp v21, v31, v4 quad_perm:[2,2,2,2] row_mask:0xf bank_mask:0xf
  s_waitcnt vmcnt(3)
  buffer_load_dwordx4 v[80:83], v2, s[52:55], s61 offen nt
  s_add_u32 s61, s61, 8192
  v_mfma_f32_16x16x16_bf16 v[12:15], v[20:21], v[64:65], v[12:15]
  v_mfma_f32_16x16x16_bf16 v[16:19], v[20:21], v[66:67], v[16:19]
  v_and_b32_dpp v22, v31, v3 quad_perm:[3,3,3,3] row_mask:0xf bank_mask:0xf
  v_and_b32_dpp v23, v31, v4 quad_perm:[3,3,3,3] row_mask:0xf bank_mask:0xf
  s_waitcnt vmcnt(3)
  buffer_load_dwordx4 v[84:87], v2, s[52:55], s61 offen nt
  s_add_u32 s61, s61, 8192
  v_mfma_f32_16x16x16_bf16 v[12:15], v[22:23], v[68:69], v[12:15]
  v_mfma_f32_16x16x16_bf16 v[16:19], v[22:23], v[70:71], v[16:19]
  v_and_b32_dpp v20, v32, v3 quad_perm:[0,0,0,0] row_mask:0xf bank_mask:0xf
  v_and_b32_dpp v21, v32, v4 quad_perm:[0,0,0,0] row_mask:0xf bank_mask:0xf
  s_waitcnt vmcnt(3)
  buffer_load_dwordx4 v[88:91], v2, s[52:55], s61 offen nt
  s_add_u32 s61, s61, 8192
  v_mfma_f32_16x16x16_bf16 v[12:15], v[20:21], v[72:73], v[12:15]
  v_mfma_f32_16x16x16_bf16 v[16:19], v[20:21], v[74:75], v[16:19]
  v_and_b32_dpp v22, v32, v3 quad_perm:[1,1,1,1] row_mask:0xf bank_mask:0xf
  v_and_b32_dpp v23, v32, v4 quad_perm:[1,1,1,1] row_mask:0xf bank_mask:0xf
  s_waitcnt vmcnt(3)
  buffer_load_dwordx4 v[92:95], v2, s[52:55], s61 offen nt
  s_add_u32 s61, s61, 8192
  v_mfma_f32_16x16x16_bf16 v[12:15], v[22:23], v[76:77], v[12:15]
  v_mfma_f32_16x16x16_bf16 v[16:19], v[22:23], v[78:79], v[16:19]
  v_and_b32_dpp v20, v32, v3 quad_perm:[2,2,2,2] row_mask:0xf bank_mask:0xf
  v_and_b32_dpp v21, v32, v4 quad_perm:[2,2,2,2] row_mask:0xf bank_mask:0xf
  s_waitcnt vmcnt(3)
  buffer_load_dwordx4 v[96:99], v2, s[52:55], s61 offen nt
  s_add_u32 s61, s61, 8192
  v_mfma_f32_16x16x16_bf16 v[12:15], v[20:21], v[80:81], v[12:15]
  v_mfma_f32_16x16x16_bf16 v[16:19], v[20:21], v[82:83], v[16:19]
  v_and_b32_dpp v22, v32, v3 quad_perm:[3,3,3,3] row_mask:0xf bank_mask:0xf
  v_and_b32_dpp v23, v32, v4 quad_perm:[3,3,3,3] row_mask:0xf bank_mask:0xf
  s_waitcnt vmcnt(3)
  buffer_load_dwordx4 v[100:103], v2, s[52:55], s61 offen nt
  s_add_u32 s61, s61, 8192
  v_mfma_f32_16x16x16_bf16 v[12:15], v[22:23], v[84:85], v[12:15]
  v_mfma_f32_16x16x16_bf16 v[16:19], v[22:23], v[86:87], v[16:19]
  v_and_b32_dpp v20, v33, v3 quad_perm:[0,0,0,0] row_mask:0xf bank_mask:0xf
  v_and_b32_dpp v21, v33, v4 quad_perm:[0,0,0,0] row_mask:0xf bank_mask:0xf
  s_waitcnt vmcnt(3)
  buffer_load_dwordx4 v[104:107], v2, s[52:55], s61 offen nt
  s_add_u32 s61, s61, 8192
  v_mfma_f32_16x16x16_bf16 v[12:15], v[20:21], v[88:89], v[12:15]
  v_mfma_f32_16x16x16_bf16 v[16:19], v[20:21], v[90:91], v[16:19]
  v_and_b32_dpp v22, v33, v3 quad_perm:[1,1,1,1] row_mask:0xf bank_mask:0xf
  v_and_b32_dpp v23, v33, v4 quad_perm:[1,1,1,1] row_mask:0xf bank_mask:0xf
  s_waitcnt vmcnt(3)
  buffer_load_dwordx4 v[108:111], v2, s[52:55], s61 offen nt
  s_add_u32 s61, s61, 8192
  v_mfma_f32_16x16x16_bf16 v[12:15], v[22:23], v[92:93], v[12:15]
  v_mfma_f32_16x16x16_bf16 v[16:19], v[22:23], v[94:95], v[16:19]
  v_and_b32_dpp v20, v33, v3 quad_perm:[2,2,2,2] row_mask:0xf bank_mask:0xf
  v_and_b32_dpp v21, v33, v4 quad_perm:[2,2,2,2] row_mask:0xf bank_mask:0xf
  s_waitcnt vmcnt(3)
  buffer_load_dwordx4 v[112:115], v2, s[52:55], s61 offen nt
  s_add_u32 s61, s61, 8192
  v_mfma_f32_16x16x16_bf16 v[12:15], v[20:21], v[96:97], v[12:15]
  v_mfma_f32_16x16x16_bf16 v[16:19], v[20:21], v[98:99], v[16:19]
  v_and_b32_dpp v22, v33, v3 quad_perm:[3,3,3,3] row_mask:0xf bank_mask:0xf
  v_and_b32_dpp v23, v33, v4 quad_perm:[3,3,3,3] row_mask:0xf bank_mask:0xf
  s_waitcnt vmcnt(3)
  buffer_load_dwordx4 v[116:119], v2, s[52:55], s61 offen nt
  s_add_u32 s61, s61, 8192
  v_mfma_f32_16x16x16_bf16 v[12:15], v[22:23], v[100:101], v[12:15]
  v_mfma_f32_16x16x16_bf16 v[16:19], v[22:23], v[102:103], v[16:19]
  v_and_b32_dpp v20, v34, v3 quad_perm:[0,0,0,0] row_mask:0xf bank_mask:0xf
  v_and_b32_dpp v21, v34, v4 quad_perm:[0,0,0,0] row_mask:0xf bank_mask:0xf
  s_waitcnt vmcnt(3)
  buffer_load_dwordx4 v[120:123], v2, s[52:55], s61 offen nt
  s_add_u32 s61, s61, 8192
  v_mfma_f32_16x16x16_bf16 v[12:15], v[20:21], v[104:105], v[12:15]
  v_mfma_f32_16x16x16_bf16 v[16:19], v[20:21], v[106:107], v[16:19]
  v_and_b32_dpp v22, v34, v3 quad_perm:[1,1,1,1] row_mask:0xf bank_mask:0xf
  v_and_b32_dpp v23, v34, v4 quad_perm:[1,1,1,1] row_mask:0xf bank_mask:0xf
  s_waitcnt vmcnt(3)
  buffer_load_dwordx4 v[124:127], v2, s[52:55], s61 offen nt
  s_add_u32 s61, s61, 8192
  v_mfma_f32_16x16x16_bf16 v[12:15], v[22:23], v[108:109], v[12:15]
  v_mfma_f32_16x16x16_bf16 v[16:19], v[22:23], v[110:111], v[16:19]
  v_and_b32_dpp v20, v34, v3 quad_perm:[2,2,2,2] row_mask:0xf bank_mask:0xf
  v_and_b32_dpp v21, v34, v4 quad_perm:[2,2,2,2] row_mask:0xf bank_mask:0xf
  s_waitcnt vmcnt(3)
  buffer_load_dwordx4 v[128:131], v2, s[52:55], s61 offen nt
  s_add_u32 s61, s61, 8192
  v_mfma_f32_16x16x16_bf16 v[12:15], v[20:21], v[112:113], v[12:15]
  v_mfma_f32_16x16x16_bf16 v[16:19], v[20:21], v[114:115], v[16:19]
  v_and_b32_dpp v22, v34, v3 quad_perm:[3,3,3,3] row_mask:0xf bank_mask:0xf
  v_and_b32_dpp v23, v34, v4 quad_perm:[3,3,3,3] row_mask:0xf bank_mask:0xf
  s_waitcnt vmcnt(3)
  buffer_load_dwordx4 v[132:135], v2, s[52:55], s61 offen nt
  s_add_u32 s61, s61, 8192
  v_mfma_f32_16x16x16_bf16 v[12:15], v[22:23], v[116:117], v[12:15]
  v_mfma_f32_16x16x16_bf16 v[16:19], v[22:23], v[118:119], v[16:19]
L_cm_9:
  ds_read_b32 v161, v162
  s_waitcnt lgkmcnt(0)
  v_readfirstlane_b32 s62, v161
  s_add_u32 s80, s80, 1
  s_cmp_gt_u32 s80, 400000
  s_cbranch_scc1 L_abort
  s_cmp_lt_u32 s62, 8
  s_cbranch_scc1 L_cm_9
  ds_read_b32 v160, v155
  ds_read_b32 v161, v156
  ds_read_b32 v164, v154
  s_waitcnt lgkmcnt(0)
  v_sub_f32 v160, v160, v161
  v_sub_f32 v164, v8, v164
  v_exp_f32 v160, v160
  v_exp_f32 v164, v164
  s_nop 0
  v_mul_f32 v164, v9, v164
  s_mov_b64 exec, s[68:69]
  ds_add_f32 v154, v164 offset:16
  s_mov_b64 exec, -1
  v_and_b32_dpp v20, v35, v3 quad_perm:[0,0,0,0] row_mask:0xf bank_mask:0xf
  v_and_b32_dpp v21, v35, v4 quad_perm:[0,0,0,0] row_mask:0xf bank_mask:0xf
  s_waitcnt vmcnt(3)
  buffer_load_dwordx4 v[136:139], v2, s[52:55], s61 offen nt
  s_add_u32 s61, s61, 8192
  v_mfma_f32_16x16x16_bf16 v[12:15], v[20:21], v[120:121], v[12:15]
  v_mfma_f32_16x16x16_bf16 v[16:19], v[20:21], v[122:123], v[16:19]
  v_and_b32_dpp v22, v35, v3 quad_perm:[1,1,1,1] row_mask:0xf bank_mask:0xf
  v_and_b32_dpp v23, v35, v4 quad_perm:[1,1,1,1] row_mask:0xf bank_mask:0xf
  s_waitcnt vmcnt(3)
  buffer_load_dwordx4 v[140:143], v2, s[52:55], s61 offen nt
  v_mfma_f32_16x16x16_bf16 v[12:15], v[22:23], v[124:125], v[12:15]
  v_mfma_f32_16x16x16_bf16 v[16:19], v[22:23], v[126:127], v[16:19]
  v_and_b32_dpp v20, v35, v3 quad_perm:[2,2,2,2] row_mask:0xf bank_mask:0xf
  v_and_b32_dpp v21, v35, v4 quad_perm:[2,2,2,2] row_mask:0xf bank_mask:0xf
  s_waitcnt vmcnt(3)
  s_nop 0
  v_mfma_f32_16x16x16_bf16 v[12:15], v[20:21], v[128:129], v[12:15]
  v_mfma_f32_16x16x16_bf16 v[16:19], v[20:21], v[130:131], v[16:19]
  v_and_b32_dpp v22, v35, v3 quad_perm:[3,3,3,3] row_mask:0xf bank_mask:0xf
  v_and_b32_dpp v23, v35, v4 quad_perm:[3,3,3,3] row_mask:0xf bank_mask:0xf
  s_waitcnt vmcnt(2)
  s_nop 0
  v_mfma_f32_16x16x16_bf16 v[12:15], v[22:23], v[132:133], v[12:15]
  v_mfma_f32_16x16x16_bf16 v[16:19], v[22:23], v[134:135], v[16:19]
  v_and_b32_dpp v20, v7, v3 quad_perm:[0,0,0,0] row_mask:0xf bank_mask:0xf
  v_and_b32_dpp v21, v7, v4 quad_perm:[0,0,0,0] row_mask:0xf bank_mask:0xf
  s_waitcnt vmcnt(1)
  s_nop 0
  v_mfma_f32_16x16x16_bf16 v[12:15], v[20:21], v[136:137], v[12:15]
  v_mfma_f32_16x16x16_bf16 v[16:19], v[20:21], v[138:139], v[16:19]
  v_and_b32_dpp v22, v7, v3 quad_perm:[1,1,1,1] row_mask:0xf bank_mask:0xf
  v_and_b32_dpp v23, v7, v4 quad_perm:[1,1,1,1] row_mask:0xf bank_mask:0xf
  s_waitcnt vmcnt(0)
  s_nop 0
  v_mfma_f32_16x16x16_bf16 v[12:15], v[22:23], v[140:141], v[12:15]
  v_mfma_f32_16x16x16_bf16 v[16:19], v[22:23], v[142:143], v[16:19]
L_att_done:
  s_nop 6
  v_mul_f32 v12, v160, v12
  v_mul_f32 v13, v160, v13
  v_mul_f32 v14, v160, v14
  v_mul_f32 v15, v160, v15
  v_mul_f32 v16, v160, v16
  v_mul_f32 v17, v160, v17
  v_mul_f32 v18, v160, v18
  v_mul_f32 v19, v160, v19
  ds_write_b128 v152, v[12:15]
  ds_write_b128 v152, v[16:19] offset:16
  s_waitcnt lgkmcnt(0)
  s_barrier
  ds_read_b64 v[24:25], v158 offset:0
  ds_read_b64 v[26:27], v158 offset:10240
  ds_read_b64 v[28:29], v158 offset:20480
  ds_read_b64 v[30:31], v158 offset:30720
  ds_read_b32 v14, v159
  ds_read_b32 v15, v159 offset:16
  s_waitcnt lgkmcnt(2)
  v_add_f32 v24, v24, v26
  v_add_f32 v25, v25, v27
  v_add_f32 v28, v28, v30
  v_add_f32 v29, v29, v31
  v_add_f32 v12, v24, v28
  v_add_f32 v13, v25, v29
  v_mov_b32 v24, v12
  v_mov_b32 v25, v13
  s_waitcnt lgkmcnt(0)
  v_rcp_f32 v16, v15
  v_log_f32 v17, v15
  v_permlane32_swap_b32 v12, v24
  v_permlane32_swap_b32 v13, v25
  v_add_f32 v12, v12, v24
  v_add_f32 v13, v13, v25
  s_mov_b32 exec_hi, 0
  v_add_f32 v21, v17, v14
  v_mul_f32 v20, v12, v16
  v_mul_f32 v22, v13, v16
  v_or_b32 v21, 1, v21
  v_or_b32 v20, 1, v20
  v_or_b32 v22, 1, v22
  v_mov_b32 v23, v21
  s_cmp_eq_u32 s75, 0
  s_cbranch_scc1 L_eslow_10
  buffer_store_dwordx4 v[20:23], v157, s[40:43], s67 offen
  s_branch L_edone_11
L_eslow_10:
  buffer_store_dwordx4 v[20:23], v157, s[40:43], s66 offen sc1
  s_mul_i32 s81, s83, 0x9E3779B1
  s_add_u32 s81, s81, 0x7F4A7C15
  s_lshl_b32 s62, s36, 3
  s_add_u32 s62, s62, s3
  s_lshl_b32 s62, s62, 7
  s_lshl_b32 s64, s37, 2
  s_add_u32 s62, s62, s64
  s_add_u32 s62, s62, 2170880
  s_waitcnt vmcnt(0)
  s_mov_b64 exec, 1
  v_mov_b32 v24, 0
  v_mov_b32 v25, s81
  buffer_store_dword v25, v24, s[40:43], s62 offen sc1
L_edone_11:
  s_endpgm
L_helper:
  s_sub_u32 s38, s3, 8
  s_mov_b32 s80, 0
  s_add_u32 s78, s34, 3145728
  s_addc_u32 s79, s35, 0
  s_load_dword s83, s[78:79], 0
  s_getreg_b32 s57, hwreg(HW_REG_XCC_ID)
  s_and_b32 s57, s57, 15
  v_and_b32 v1, 15, v0
  v_lshrrev_b32 v2, 4, v0
  s_cmp_lg_u32 s38, 0
  s_cbranch_scc1 L_noinit_12
  v_mov_b32 v38, 152960
  v_mov_b32 v39, 0
  ds_write_b32 v38, v39
L_noinit_12:
  s_lshl_b32 s67, s38, 10
  s_add_u32 s67, s67, 148736
  v_lshlrev_b32 v4, 4, v2
  v_add_u32 v4, s67, v4
  v_lshlrev_b32 v5, 4, v0
  v_add_u32 v5, s67, v5
  s_cmp_lt_u32 s37, 8
  s_cbranch_scc1 L_role_wq
  s_cmp_lt_u32 s37, 16
  s_cbranch_scc1 L_role_wo
  s_cmp_lt_u32 s37, 22
  s_cbranch_scc1 L_role_mod
  s_cmp_lt_u32 s37, 29
  s_cbranch_scc1 L_role_ffn
  s_branch L_role_fin
L_role_wq:
  s_lshl_b32 s62, s36, 10
  s_lshl_b32 s61, s37, 7
  s_add_u32 s62, s62, s61
  s_mov_b32 s48, s14
  s_and_b32 s49, s15, 0xffff
  s_mov_b32 s50, 4194304
  s_mov_b32 s51, 0x00020000
  v_lshrrev_b32 v158, 3, v0
  s_mov_b32 s61, 8192
  v_mul_lo_u32 v158, v158, s61
  v_and_b32 v7, 7, v0
  v_lshl_add_u32 v158, v7, 4, v158
  s_mul_i32 s61, s38, 1048576
  s_add_u32 s72, s62, s61
  s_lshl_b32 s66, s38, 14
  s_add_u32 s66, s66, 0
  s_mov_b32 s52, s8
  s_and_b32 s53, s9, 0xffff
  s_mov_b32 s54, 1024
  s_mov_b32 s55, 0x00020000
  v_lshlrev_b32 v7, 4, v0
  buffer_load_dwordx4 v[12:15], v7, s[52:55], 0 offen
  s_add_u32 m0, s66, 0
  s_nop 0
  buffer_load_dwordx4 v158, s[48:51], s72 offen nt lds
  s_add_u32 s72, s72, 65536
  s_add_u32 m0, s66, 1024
  s_nop 0
  buffer_load_dwordx4 v158, s[48:51], s72 offen nt lds
  s_add_u32 s72, s72, 65536
  s_add_u32 m0, s66, 2048
  s_nop 0
  buffer_load_dwordx4 v158, s[48:51], s72 offen nt lds
  s_add_u32 s72, s72, 65536
  s_add_u32 m0, s66, 3072
  s_nop 0
  buffer_load_dwordx4 v158, s[48:51], s72 offen nt lds
  s_add_u32 s72, s72, 65536
  s_add_u32 m0, s66, 4096
  s_nop 0
  buffer_load_dwordx4 v158, s[48:51], s72 offen nt lds
  s_add_u32 s72, s72, 65536
  s_add_u32 m0, s66, 5120
  s_nop 0
  buffer_load_dwordx4 v158, s[48:51], s72 offen nt lds
  s_add_u32 s72, s72, 65536
  s_add_u32 m0, s66, 6144
  s_nop 0
  buffer_load_dwordx4 v158, s[48:51], s72 offen nt lds
  s_add_u32 s72, s72, 65536
  s_add_u32 m0, s66, 7168
  s_nop 0
  buffer_load_dwordx4 v158, s[48:51], s72 offen nt lds
  s_add_u32 s72, s72, 65536
  s_add_u32 m0, s66, 8192
  s_nop 0
  buffer_load_dwordx4 v158, s[48:51], s72 offen nt lds
  s_add_u32 s72, s72, 65536
  s_add_u32 m0, s66, 9216
  s_nop 0
  buffer_load_dwordx4 v158, s[48:51], s72 offen nt lds
  s_add_u32 s72, s72, 65536
  s_add_u32 m0, s66, 10240
  s_nop 0
  buffer_load_dwordx4 v158, s[48:51], s72 offen nt lds
  s_add_u32 s72, s72, 65536
  s_add_u32 m0, s66, 11264
  s_nop 0
  buffer_load_dwordx4 v158, s[48:51], s72 offen nt lds
  s_add_u32 s72, s72, 65536
  s_add_u32 m0, s66, 12288
  s_nop 0
  buffer_load_dwordx4 v158, s[48:51], s72 offen nt lds
  s_add_u32 s72, s72, 65536
  s_add_u32 m0, s66, 13312
  s_nop 0
  buffer_load_dwordx4 v158, s[48:51], s72 offen nt lds
  s_add_u32 s72, s72, 65536
  s_add_u32 m0, s66, 14336
  s_nop 0
  buffer_load_dwordx4 v158, s[48:51], s72 offen nt lds
  s_add_u32 s72, s72, 65536
  s_add_u32 m0, s66, 15360
  s_nop 0
  buffer_load_dwordx4 v158, s[48:51], s72 offen nt lds
  s_waitcnt lgkmcnt(0)
  s_barrier
  s_waitcnt vmcnt(0)
  v_mov_b32 v38, 152960
  v_mov_b32 v39, 1
  s_mov_b64 exec, 1
  ds_add_u32 v38, v39
  s_mov_b64 exec, -1
L_ls_13:
  ds_read_b32 v39, v38
  s_waitcnt lgkmcnt(0)
  v_readfirstlane_b32 s82, v39
  s_add_u32 s80, s80, 1
  s_cmp_gt_u32 s80, 400000
  s_cbranch_scc1 L_abort
  s_cmp_lt_u32 s82, 4
  s_cbranch_scc1 L_ls_13
  v_lshrrev_b32 v3, 2, v1
  v_lshl_add_u32 v3, v2, 3, v3
  v_lshlrev_b32 v3, 7, v3
  v_and_b32 v7, 3, v0
  v_lshl_add_u32 v3, v7, 3, v3
  s_lshl_b32 s61, s38, 5
  s_add_u32 s61, s61, 0
  v_add_u32 v3, s61, v3
  ds_read_b64_tr_b16 v[40:41], v3 offset:0
  ds_read_b64_tr_b16 v[42:43], v3 offset:512
  ds_read_b64_tr_b16 v[44:45], v3 offset:4096
  ds_read_b64_tr_b16 v[46:47], v3 offset:4608
  ds_read_b64_tr_b16 v[48:49], v3 offset:8192
  ds_read_b64_tr_b16 v[50:51], v3 offset:8704
  ds_read_b64_tr_b16 v[52:53], v3 offset:12288
  ds_read_b64_tr_b16 v[54:55], v3 offset:12800
  ds_read_b64_tr_b16 v[56:57], v3 offset:16384
  ds_read_b64_tr_b16 v[58:59], v3 offset:16896
  s_waitcnt lgkmcnt(4)
  ds_read_b64_tr_b16 v[60:61], v3 offset:20480
  ds_read_b64_tr_b16 v[62:63], v3 offset:20992
  ds_read_b64_tr_b16 v[64:65], v3 offset:24576
  ds_read_b64_tr_b16 v[66:67], v3 offset:25088
  ds_read_b64_tr_b16 v[68:69], v3 offset:28672
  ds_read_b64_tr_b16 v[70:71], v3 offset:29184
  ds_read_b64_tr_b16 v[72:73], v3 offset:32768
  ds_read_b64_tr_b16 v[74:75], v3 offset:33280
  ds_read_b64_tr_b16 v[76:77], v3 offset:36864
  ds_read_b64_tr_b16 v[78:79], v3 offset:37376
  s_waitcnt lgkmcnt(4)
  ds_read_b64_tr_b16 v[80:81], v3 offset:40960
  ds_read_b64_tr_b16 v[82:83], v3 offset:41472
  ds_read_b64_tr_b16 v[84:85], v3 offset:45056
  ds_read_b64_tr_b16 v[86:87], v3 offset:45568
  ds_read_b64_tr_b16 v[88:89], v3 offset:49152
  ds_read_b64_tr_b16 v[90:91], v3 offset:49664
  ds_read_b64_tr_b16 v[92:93], v3 offset:53248
  ds_read_b64_tr_b16 v[94:95], v3 offset:53760
  ds_read_b64_tr_b16 v[96:97], v3 offset:57344
  ds_read_b64_tr_b16 v[98:99], v3 offset:57856
  s_waitcnt lgkmcnt(4)
  ds_read_b64_tr_b16 v[100:101], v3 offset:61440
  ds_read_b64_tr_b16 v[102:103], v3 offset:61952
  s_waitcnt lgkmcnt(0)
  v_mov_b32 v38, 152960
  v_mov_b32 v39, 1
  s_mov_b64 exec, 1
  ds_add_u32 v38, v39
  s_mov_b64 exec, -1
  s_cmp_lg_u32 s38, 0
  s_cbranch_scc1 L_h0e_15
  v_mov_b32 v8, 0
  v_mov_b32 v9, 0
  v_mov_b32 v10, 0
  v_mov_b32 v11, 0
  v_lshlrev_b32 v6, 4, v0
  s_lshl_b32 s60, s36, 5
  s_add_u32 s60, s60, s37
  s_lshl_b32 s60, s60, 12
  s_add_u32 s60, s60, 5242880
  buffer_store_dwordx4 v[8:11], v6, s[40:43], s60 offen offset:0
  buffer_store_dwordx4 v[8:11], v6, s[40:43], s60 offen offset:1024
  buffer_store_dwordx4 v[8:11], v6, s[40:43], s60 offen offset:2048
  buffer_store_dwordx4 v[8:11], v6, s[40:43], s60 offen offset:3072
  s_mov_b64 exec, -1
L_h0e_15:
  s_waitcnt lgkmcnt(0)
  s_mul_i32 s81, s83, 0x9E3779B1
  s_add_u32 s81, s81, 0x7F4A7C15
  s_cmp_lg_u32 s38, 0
  s_cbranch_scc1 L_h0e_16
  v_lshlrev_b32 v16, 16, v12
  v_and_b32 v17, 0xffff0000, v12
  v_lshlrev_b32 v18, 16, v13
  v_and_b32 v19, 0xffff0000, v13
  v_lshlrev_b32 v20, 16, v14
  v_and_b32 v21, 0xffff0000, v14
  v_lshlrev_b32 v22, 16, v15
  v_and_b32 v23, 0xffff0000, v15
  v_add_f32 v24, v16, v17
  v_add_f32 v24, v24, v18
  v_add_f32 v24, v24, v19
  v_add_f32 v24, v24, v20
  v_add_f32 v24, v24, v21
  v_add_f32 v24, v24, v22
  v_add_f32 v24, v24, v23
  s_nop 1
  v_add_f32_dpp v24, v24, v24 quad_perm:[1,0,3,2] row_mask:0xf bank_mask:0xf
  s_nop 1
  v_add_f32_dpp v24, v24, v24 quad_perm:[2,3,0,1] row_mask:0xf bank_mask:0xf
  s_nop 1
  v_add_f32_dpp v24, v24, v24 row_half_mirror row_mask:0xf bank_mask:0xf
  s_nop 1
  v_add_f32_dpp v24, v24, v24 row_mirror row_mask:0xf bank_mask:0xf
  v_mov_b32 v26, v24
  s_nop 1
  v_permlane16_swap_b32 v24, v26
  v_add_f32 v24, v24, v26
  v_mov_b32 v26, v24
  s_nop 1
  v_permlane32_swap_b32 v24, v26
  v_add_f32 v24, v24, v26
  v_mul_f32 v24, 0x3b000000, v24
  v_sub_f32 v28, v16, v24
  v_sub_f32 v29, v17, v24
  v_sub_f32 v30, v18, v24
  v_sub_f32 v31, v19, v24
  v_sub_f32 v32, v20, v24
  v_sub_f32 v33, v21, v24
  v_sub_f32 v34, v22, v24
  v_sub_f32 v35, v23, v24
  v_mul_f32 v25, v28, v28
  v_fmac_f32 v25, v29, v29
  v_fmac_f32 v25, v30, v30
  v_fmac_f32 v25, v31, v31
  v_fmac_f32 v25, v32, v32
  v_fmac_f32 v25, v33, v33
  v_fmac_f32 v25, v34, v34
  v_fmac_f32 v25, v35, v35
  s_nop 1
  v_add_f32_dpp v25, v25, v25 quad_perm:[1,0,3,2] row_mask:0xf bank_mask:0xf
  s_nop 1
  v_add_f32_dpp v25, v25, v25 quad_perm:[2,3,0,1] row_mask:0xf bank_mask:0xf
  s_nop 1
  v_add_f32_dpp v25, v25, v25 row_half_mirror row_mask:0xf bank_mask:0xf
  s_nop 1
  v_add_f32_dpp v25, v25, v25 row_mirror row_mask:0xf bank_mask:0xf
  v_mov_b32 v26, v25
  s_nop 1
  v_permlane16_swap_b32 v25, v26
  v_add_f32 v25, v25, v26
  v_mov_b32 v26, v25
  s_nop 1
  v_permlane32_swap_b32 v25, v26
  v_add_f32 v25, v25, v26
  v_mul_f32 v25, 0x3b000000, v25
  v_cvt_pk_bf16_f32 v26, v24, v25
  v_lshlrev_b32 v24, 16, v26
  v_and_b32 v25, 0xffff0000, v26
  v_add_f32 v25, 0x3727c5ac, v25
  v_cvt_pk_bf16_f32 v26, v25, v25
  v_lshlrev_b32 v25, 16, v26
  v_sqrt_f32 v25, v25
  s_nop 0
  v_cvt_pk_bf16_f32 v26, v25, v25
  v_lshlrev_b32 v25, 16, v26
  v_rcp_f32 v27, v25
  v_sub_f32 v16, v16, v24
  v_sub_f32 v17, v17, v24
  v_sub_f32 v18, v18, v24
  v_sub_f32 v19, v19, v24
  v_sub_f32 v20, v20, v24
  v_sub_f32 v21, v21, v24
  v_sub_f32 v22, v22, v24
  v_sub_f32 v23, v23, v24
  v_cvt_pk_bf16_f32 v28, v16, v17
  v_lshlrev_b32 v16, 16, v28
  v_and_b32 v17, 0xffff0000, v28
  v_cvt_pk_bf16_f32 v29, v18, v19
  v_lshlrev_b32 v18, 16, v29
  v_and_b32 v19, 0xffff0000, v29
  v_cvt_pk_bf16_f32 v28, v20, v21
  v_lshlrev_b32 v20, 16, v28
  v_and_b32 v21, 0xffff0000, v28
  v_cvt_pk_bf16_f32 v29, v22, v23
  v_lshlrev_b32 v22, 16, v29
  v_and_b32 v23, 0xffff0000, v29
  v_mul_f32 v28, v16, v27
  v_mul_f32 v29, v17, v27
  v_mul_f32 v30, v18, v27
  v_mul_f32 v31, v19, v27
  v_mul_f32 v32, v20, v27
  v_mul_f32 v33, v21, v27
  v_mul_f32 v34, v22, v27
  v_mul_f32 v35, v23, v27
  v_fma_f32 v16, -v28, v25, v16
  v_fma_f32 v17, -v29, v25, v17
  v_fma_f32 v18, -v30, v25, v18
  v_fma_f32 v19, -v31, v25, v19
  v_fma_f32 v20, -v32, v25, v20
  v_fma_f32 v21, -v33, v25, v21
  v_fma_f32 v22, -v34, v25, v22
  v_fma_f32 v23, -v35, v25, v23
  v_fma_f32 v16, v16, v27, v28
  v_fma_f32 v17, v17, v27, v29
  v_fma_f32 v18, v18, v27, v30
  v_fma_f32 v19, v19, v27, v31
  v_fma_f32 v20, v20, v27, v32
  v_fma_f32 v21, v21, v27, v33
  v_fma_f32 v22, v22, v27, v34
  v_fma_f32 v23, v23, v27, v35
  v_cvt_pk_bf16_f32 v26, v16, v17
  v_lshlrev_b32 v16, 16, v26
  v_and_b32 v17, 0xffff0000, v26
  v_cvt_pk_bf16_f32 v27, v18, v19
  v_lshlrev_b32 v18, 16, v27
  v_and_b32 v19, 0xffff0000, v27
  v_cvt_pk_bf16_f32 v26, v20, v21
  v_lshlrev_b32 v20, 16, v26
  v_and_b32 v21, 0xffff0000, v26
  v_cvt_pk_bf16_f32 v27, v22, v23
  v_lshlrev_b32 v22, 16, v27
  v_and_b32 v23, 0xffff0000, v27
  s_cmp_lg_u32 s38, 0
  s_cbranch_scc1 L_h0e_17
  s_waitcnt vmcnt(0)
  s_lshl_b32 s60, s36, 7
  s_lshl_b32 s61, s37, 2
  s_add_u32 s60, s60, s61
  s_add_u32 s60, s60, 2162688
  s_mov_b64 exec, 1
  s_xor_b32 s61, s81, s57
  v_mov_b32 v38, 0
  v_mov_b32 v39, s61
  buffer_store_dword v39, v38, s[40:43], s60 offen sc1
  s_mov_b64 exec, -1
L_h0e_17:
  s_lshl_b32 s61, s37, 2
  s_add_u32 s61, s61, 3
  s_lshl_b32 s61, s61, 7
  s_mov_b32 s60, 0
  s_add_u32 s61, s61, s60
  s_add_u32 s61, s61, 2359300
  v_mov_b32 v8, 0
  s_branch L_sn2_19
L_sn_18:
  s_sleep 8
L_sn2_19:
  buffer_load_dword v9, v8, s[40:43], s61 offen sc1
  s_waitcnt vmcnt(0)
  v_readfirstlane_b32 s82, v9
  s_add_u32 s80, s80, 1
  s_cmp_gt_u32 s80, 400000
  s_cbranch_scc1 L_abort
  s_cmp_eq_u32 s82, s81
  s_cbranch_scc0 L_sn_18
  v_lshlrev_b32 v6, 5, v0
  s_mov_b32 s60, 0
  s_add_u32 s60, s60, 2359296
L_mp_20:
  buffer_load_dwordx4 v[104:107], v6, s[40:43], s60 offen sc1
  buffer_load_dwordx4 v[108:111], v6, s[40:43], s60 offen offset:16 sc1
  buffer_load_dwordx4 v[112:115], v6, s[40:43], s60 offen offset:2048 sc1
  buffer_load_dwordx4 v[116:119], v6, s[40:43], s60 offen offset:2064 sc1
  s_waitcnt vmcnt(0)
  v_xor_b32 v105, s81, v105
  v_xor_b32 v107, s81, v107
  v_xor_b32 v109, s81, v109
  v_xor_b32 v111, s81, v111
  v_xor_b32 v113, s81, v113
  v_xor_b32 v115, s81, v115
  v_xor_b32 v117, s81, v117
  v_xor_b32 v119, s81, v119
  v_or3_b32 v8, v105, v107, v109
  v_or3_b32 v8, v8, v111, v113
  v_or3_b32 v8, v8, v115, v117
  v_or_b32 v8, v8, v119
  v_cmp_eq_u32 vcc, 0, v8
  s_add_u32 s80, s80, 1
  s_cmp_gt_u32 s80, 400000
  s_cbranch_scc1 L_abort
  s_cmp_eq_u64 vcc, exec
  s_cbranch_scc1 L_pk_21
  s_sleep 8
  s_branch L_mp_20
L_pk_21:
  v_lshlrev_b32 v24, 16, v104
  v_and_b32 v25, 0xffff0000, v104
  v_lshlrev_b32 v26, 16, v106
  v_and_b32 v27, 0xffff0000, v106
  v_lshlrev_b32 v28, 16, v108
  v_and_b32 v29, 0xffff0000, v108
  v_lshlrev_b32 v30, 16, v110
  v_and_b32 v31, 0xffff0000, v110
  v_lshlrev_b32 v32, 16, v112
  v_and_b32 v33, 0xffff0000, v112
  v_lshlrev_b32 v34, 16, v114
  v_and_b32 v35, 0xffff0000, v114
  v_lshlrev_b32 v36, 16, v116
  v_and_b32 v37, 0xffff0000, v116
  v_lshlrev_b32 v38, 16, v118
  v_and_b32 v39, 0xffff0000, v118
  v_add_f32 v32, 1.0, v32
  v_add_f32 v33, 1.0, v33
  v_add_f32 v34, 1.0, v34
  v_add_f32 v35, 1.0, v35
  v_add_f32 v36, 1.0, v36
  v_add_f32 v37, 1.0, v37
  v_add_f32 v38, 1.0, v38
  v_add_f32 v39, 1.0, v39
  v_cvt_pk_bf16_f32 v8, v32, v33
  v_lshlrev_b32 v32, 16, v8
  v_and_b32 v33, 0xffff0000, v8
  v_cvt_pk_bf16_f32 v9, v34, v35
  v_lshlrev_b32 v34, 16, v9
  v_and_b32 v35, 0xffff0000, v9
  v_cvt_pk_bf16_f32 v8, v36, v37
  v_lshlrev_b32 v36, 16, v8
  v_and_b32 v37, 0xffff0000, v8
  v_cvt_pk_bf16_f32 v9, v38, v39
  v_lshlrev_b32 v38, 16, v9
  v_and_b32 v39, 0xffff0000, v9
  v_mul_f32 v16, v16, v32
  v_mul_f32 v17, v17, v33
  v_mul_f32 v18, v18, v34
  v_mul_f32 v19, v19, v35
  v_mul_f32 v20, v20, v36
  v_mul_f32 v21, v21, v37
  v_mul_f32 v22, v22, v38
  v_mul_f32 v23, v23, v39
  v_cvt_pk_bf16_f32 v8, v16, v17
  v_lshlrev_b32 v16, 16, v8
  v_and_b32 v17, 0xffff0000, v8
  v_cvt_pk_bf16_f32 v9, v18, v19
  v_lshlrev_b32 v18, 16, v9
  v_and_b32 v19, 0xffff0000, v9
  v_cvt_pk_bf16_f32 v8, v20, v21
  v_lshlrev_b32 v20, 16, v8
  v_and_b32 v21, 0xffff0000, v8
  v_cvt_pk_bf16_f32 v9, v22, v23
  v_lshlrev_b32 v22, 16, v9
  v_and_b32 v23, 0xffff0000, v9
  v_add_f32 v16, v16, v24
  v_add_f32 v17, v17, v25
  v_add_f32 v18, v18, v26
  v_add_f32 v19, v19, v27
  v_add_f32 v20, v20, v28
  v_add_f32 v21, v21, v29
  v_add_f32 v22, v22, v30
  v_add_f32 v23, v23, v31
  v_cvt_pk_bf16_f32 v8, v16, v17
  v_cvt_pk_bf16_f32 v9, v18, v19
  v_cvt_pk_bf16_f32 v10, v20, v21
  v_cvt_pk_bf16_f32 v11, v22, v23
  ds_write_b128 v5, v[8:11]
  s_waitcnt lgkmcnt(0)
L_h0e_16:
  v_mov_b32 v38, 152960
  v_mov_b32 v39, 1
  s_mov_b64 exec, 1
  ds_add_u32 v38, v39
  s_mov_b64 exec, -1
  s_branch L_ls2_23
L_ls_22:
  s_sleep 2
L_ls2_23:
  ds_read_b32 v39, v38
  s_waitcnt lgkmcnt(0)
  v_readfirstlane_b32 s82, v39
  s_add_u32 s80, s80, 1
  s_cmp_gt_u32 s80, 400000
  s_cbranch_scc1 L_abort
  s_cmp_lt_u32 s82, 12
  s_cbranch_scc1 L_ls_22
  v_lshlrev_b32 v4, 4, v2
  v_add_u32 v4, 148736, v4
  ds_read_b128 v[8:11], v4 offset:0
  ds_read_b128 v[12:15], v4 offset:64
  ds_read_b128 v[16:19], v4 offset:128
  ds_read_b128 v[20:23], v4 offset:192
  ds_read_b128 v[24:27], v4 offset:256
  ds_read_b128 v[28:31], v4 offset:320
  ds_read_b128 v[32:35], v4 offset:384
  ds_read_b128 v[36:39], v4 offset:448
  s_waitcnt lgkmcnt(7)
  v_mfma_f32_16x16x32_bf16 v[104:107], v[8:11], v[40:43], 0
  ds_read_b128 v[8:11], v4 offset:512
  s_waitcnt lgkmcnt(7)
  v_mfma_f32_16x16x32_bf16 v[108:111], v[12:15], v[44:47], 0
  ds_read_b128 v[12:15], v4 offset:576
  s_waitcnt lgkmcnt(7)
  v_mfma_f32_16x16x32_bf16 v[104:107], v[16:19], v[48:51], v[104:107]
  ds_read_b128 v[16:19], v4 offset:640
  s_waitcnt lgkmcnt(7)
  v_mfma_f32_16x16x32_bf16 v[108:111], v[20:23], v[52:55], v[108:111]
  ds_read_b128 v[20:23], v4 offset:704
  s_waitcnt lgkmcnt(7)
  v_mfma_f32_16x16x32_bf16 v[104:107], v[24:27], v[56:59], v[104:107]
  ds_read_b128 v[24:27], v4 offset:768
  s_waitcnt lgkmcnt(7)
  v_mfma_f32_16x16x32_bf16 v[108:111], v[28:31], v[60:63], v[108:111]
  ds_read_b128 v[28:31], v4 offset:832
  s_waitcnt lgkmcnt(7)
  v_mfma_f32_16x16x32_bf16 v[104:107], v[32:35], v[64:67], v[104:107]
  ds_read_b128 v[32:35], v4 offset:896
  s_waitcnt lgkmcnt(7)
  v_mfma_f32_16x16x32_bf16 v[108:111], v[36:39], v[68:71], v[108:111]
  ds_read_b128 v[36:39], v4 offset:960
  s_waitcnt lgkmcnt(7)
  v_mfma_f32_16x16x32_bf16 v[104:107], v[8:11], v[72:75], v[104:107]
  s_waitcnt lgkmcnt(6)
  v_mfma_f32_16x16x32_bf16 v[108:111], v[12:15], v[76:79], v[108:111]
  s_waitcnt lgkmcnt(5)
  v_mfma_f32_16x16x32_bf16 v[104:107], v[16:19], v[80:83], v[104:107]
  s_waitcnt lgkmcnt(4)
  v_mfma_f32_16x16x32_bf16 v[108:111], v[20:23], v[84:87], v[108:111]
  s_waitcnt lgkmcnt(3)
  v_mfma_f32_16x16x32_bf16 v[104:107], v[24:27], v[88:91], v[104:107]
  s_waitcnt lgkmcnt(2)
  v_mfma_f32_16x16x32_bf16 v[108:111], v[28:31], v[92:95], v[108:111]
  s_waitcnt lgkmcnt(1)
  v_mfma_f32_16x16x32_bf16 v[104:107], v[32:35], v[96:99], v[104:107]
  s_waitcnt lgkmcnt(0)
  v_mfma_f32_16x16x32_bf16 v[108:111], v[36:39], v[100:103], v[108:111]
  s_nop 7
  v_add_f32 v104, v104, v108
  s_lshl_b32 s60, s36, 11
  s_lshl_b32 s61, s37, 8
  s_add_u32 s60, s60, s61
  s_lshl_b32 s61, s38, 6
  s_add_u32 s60, s60, s61
  s_add_u32 s60, s60, 2113536
  v_mov_b32_dpp v105, v104 quad_perm:[1,1,3,3] row_mask:0xf bank_mask:0xf
  v_cvt_pk_bf16_f32 v104, v104, v105
  v_mov_b32 v105, s81
  v_lshlrev_b32 v6, 2, v1
  s_mov_b64 exec, 0x5555
  buffer_store_dwordx2 v[104:105], v6, s[40:43], s60 offen sc1
  s_mov_b64 exec, -1
  s_cmp_lg_u32 s38, 0
  s_cbranch_scc1 L_h0e_24
  s_lshl_b32 s61, s37, 7
  s_mov_b32 s60, 0
  s_add_u32 s61, s61, s60
  s_add_u32 s61, s61, 2359300
  s_and_b32 s61, s37, 15
  s_lshl_b32 s61, s61, 7
  s_lshl_b32 s60, s36, 11
  s_add_u32 s61, s61, s60
  s_add_u32 s61, s61, 2113540
  v_mov_b32 v8, 0
  s_branch L_sn2_26
L_sn_25:
  s_sleep 24
L_sn2_26:
  buffer_load_dword v9, v8, s[40:43], s61 offen sc1
  s_waitcnt vmcnt(0)
  v_readfirstlane_b32 s82, v9
  s_add_u32 s80, s80, 1
  s_cmp_gt_u32 s80, 400000
  s_cbranch_scc1 L_abort
  s_cmp_eq_u32 s82, s81
  s_cbranch_scc0 L_sn_25
  s_lshl_b32 s60, s36, 11
  s_add_u32 s60, s60, 2113536
  v_lshlrev_b32 v6, 5, v0
  v_and_b32 v7, 31, v0
  v_lshlrev_b32 v7, 2, v7
  s_lshl_b32 s61, s36, 7
  s_add_u32 s61, s61, 2162688
L_qp_27:
  buffer_load_dwordx4 v[8:11], v6, s[40:43], s60 offen sc1
  buffer_load_dwordx4 v[12:15], v6, s[40:43], s60 offen offset:16 sc1
  buffer_load_dword v17, v7, s[40:43], s61 offen sc1
  s_waitcnt vmcnt(0)
  v_xor_b32 v9, s81, v9
  v_xor_b32 v11, s81, v11
  v_xor_b32 v13, s81, v13
  v_xor_b32 v15, s81, v15
  v_xor_b32 v17, s81, v17
  v_mov_b32 v18, v17
  v_lshrrev_b32 v17, 4, v17
  v_or3_b32 v16, v9, v11, v13
  v_or3_b32 v16, v16, v15, v17
  v_cmp_eq_u32 vcc, 0, v16
  s_add_u32 s80, s80, 1
  s_cmp_gt_u32 s80, 400000
  s_cbranch_scc1 L_abort
  s_cmp_eq_u64 vcc, exec
  s_cbranch_scc1 L_pk_28
  s_sleep 4
  s_branch L_qp_27
L_pk_28:
  v_cmp_eq_u32 vcc, s57, v18
  s_nop 0
  s_cmp_eq_u64 vcc, exec
  s_cselect_b32 s58, 1, 0
  v_mov_b32 v9, v10
  v_mov_b32 v10, v12
  v_mov_b32 v11, v14
  v_lshlrev_b32 v6, 4, v0
  v_add_u32 v6, 147712, v6
  ds_write_b128 v6, v[8:11]
  v_mov_b32 v12, 153064
  v_mov_b32 v13, s58
  s_mov_b64 exec, 1
  ds_write_b32 v12, v13
  s_mov_b64 exec, -1
  s_waitcnt lgkmcnt(0)
L_h0e_24:
  s_barrier
  v_mov_b32 v38, 153064
  ds_read_b32 v39, v38
  s_waitcnt lgkmcnt(0)
  v_readfirstlane_b32 s58, v39
  s_branch L_tail_plain
L_role_wo:
  s_lshl_b32 s62, s36, 19
  s_sub_u32 s61, s37, 8
  s_lshl_b32 s61, s61, 7
  s_add_u32 s62, s62, s61
  s_mov_b32 s48, s16
  s_and_b32 s49, s17, 0xffff
  s_mov_b32 s50, 4194304
  s_mov_b32 s51, 0x00020000
  v_lshrrev_b32 v158, 3, v0
  s_mov_b32 s61, 1024
  v_mul_lo_u32 v158, v158, s61
  v_and_b32 v7, 7, v0
  v_lshl_add_u32 v158, v7, 4, v158
  s_mul_i32 s61, s38, 131072
  s_add_u32 s72, s62, s61
  s_lshl_b32 s66, s38, 14
  s_add_u32 s66, s66, 0
  s_waitcnt lgkmcnt(0)
  s_barrier
  s_add_u32 m0, s66, 0
  s_nop 0
  buffer_load_dwordx4 v158, s[48:51], s72 offen nt lds
  s_add_u32 s72, s72, 8192
  s_add_u32 m0, s66, 1024
  s_nop 0
  buffer_load_dwordx4 v158, s[48:51], s72 offen nt lds
  s_add_u32 s72, s72, 8192
  s_add_u32 m0, s66, 2048
  s_nop 0
  buffer_load_dwordx4 v158, s[48:51], s72 offen nt lds
  s_add_u32 s72, s72, 8192
  s_add_u32 m0, s66, 3072
  s_nop 0
  buffer_load_dwordx4 v158, s[48:51], s72 offen nt lds
  s_add_u32 s72, s72, 8192
  s_waitcnt vmcnt(3)
  s_add_u32 m0, s66, 4096
  s_nop 0
  buffer_load_dwordx4 v158, s[48:51], s72 offen nt lds
  s_add_u32 s72, s72, 8192
  s_waitcnt vmcnt(3)
  s_add_u32 m0, s66, 5120
  s_nop 0
  buffer_load_dwordx4 v158, s[48:51], s72 offen nt lds
  s_add_u32 s72, s72, 8192
  s_waitcnt vmcnt(3)
  s_add_u32 m0, s66, 6144
  s_nop 0
  buffer_load_dwordx4 v158, s[48:51], s72 offen nt lds
  s_add_u32 s72, s72, 8192
  s_waitcnt vmcnt(3)
  s_add_u32 m0, s66, 7168
  s_nop 0
  buffer_load_dwordx4 v158, s[48:51], s72 offen nt lds
  s_add_u32 s72, s72, 8192
  s_waitcnt vmcnt(3)
  s_add_u32 m0, s66, 8192
  s_nop 0
  buffer_load_dwordx4 v158, s[48:51], s72 offen nt lds
  s_add_u32 s72, s72, 8192
  s_waitcnt vmcnt(3)
  s_add_u32 m0, s66, 9216
  s_nop 0
  buffer_load_dwordx4 v158, s[48:51], s72 offen nt lds
  s_add_u32 s72, s72, 8192
  s_waitcnt vmcnt(3)
  s_add_u32 m0, s66, 10240
  s_nop 0
  buffer_load_dwordx4 v158, s[48:51], s72 offen nt lds
  s_add_u32 s72, s72, 8192
  s_waitcnt vmcnt(3)
  s_add_u32 m0, s66, 11264
  s_nop 0
  buffer_load_dwordx4 v158, s[48:51], s72 offen nt lds
  s_add_u32 s72, s72, 8192
  s_waitcnt vmcnt(3)
  s_add_u32 m0, s66, 12288
  s_nop 0
  buffer_load_dwordx4 v158, s[48:51], s72 offen nt lds
  s_add_u32 s72, s72, 8192
  s_waitcnt vmcnt(3)
  s_add_u32 m0, s66, 13312
  s_nop 0
  buffer_load_dwordx4 v158, s[48:51], s72 offen nt lds
  s_add_u32 s72, s72, 8192
  s_waitcnt vmcnt(3)
  s_add_u32 m0, s66, 14336
  s_nop 0
  buffer_load_dwordx4 v158, s[48:51], s72 offen nt lds
  s_add_u32 s72, s72, 8192
  s_waitcnt vmcnt(3)
  s_add_u32 m0, s66, 15360
  s_nop 0
  buffer_load_dwordx4 v158, s[48:51], s72 offen nt lds
  s_cmp_lg_u32 s38, 0
  s_cbranch_scc1 L_h0e_29
  v_mov_b32 v8, 0
  v_mov_b32 v9, 0
  v_mov_b32 v10, 0
  v_mov_b32 v11, 0
  v_lshlrev_b32 v6, 4, v0
  s_lshl_b32 s60, s36, 5
  s_add_u32 s60, s60, s37
  s_lshl_b32 s60, s60, 12
  s_add_u32 s60, s60, 5242880
  buffer_store_dwordx4 v[8:11], v6, s[40:43], s60 offen offset:0
  buffer_store_dwordx4 v[8:11], v6, s[40:43], s60 offen offset:1024
  buffer_store_dwordx4 v[8:11], v6, s[40:43], s60 offen offset:2048
  buffer_store_dwordx4 v[8:11], v6, s[40:43], s60 offen offset:3072
  s_lshl_b32 s60, s36, 11
  s_sub_u32 s61, s37, 8
  s_lshl_b32 s61, s61, 8
  s_add_u32 s60, s60, s61
  s_add_u32 s60, s60, 1310720
  s_add_u32 s61, s60, 65536
  v_lshlrev_b32 v6, 14, v2
  v_lshl_add_u32 v6, v1, 4, v6
  s_mov_b32 exec_lo, 0xffffffff
  s_mov_b32 exec_hi, 0x0
  buffer_store_dwordx4 v[8:11], v6, s[40:43], s60 offen sc1
  s_mov_b64 exec, -1
L_h0e_29:
  s_waitcnt lgkmcnt(0)
  s_mul_i32 s81, s83, 0x9E3779B1
  s_add_u32 s81, s81, 0x7F4A7C15
  s_waitcnt vmcnt(0)
  v_mov_b32 v38, 152960
  v_mov_b32 v39, 1
  s_mov_b64 exec, 1
  ds_add_u32 v38, v39
  s_mov_b64 exec, -1
L_ls_30:
  ds_read_b32 v39, v38
  s_waitcnt lgkmcnt(0)
  v_readfirstlane_b32 s82, v39
  s_add_u32 s80, s80, 1
  s_cmp_gt_u32 s80, 400000
  s_cbranch_scc1 L_abort
  s_cmp_lt_u32 s82, 4
  s_cbranch_scc1 L_ls_30
  v_lshrrev_b32 v3, 2, v1
  v_lshl_add_u32 v3, v2, 3, v3
  v_lshlrev_b32 v3, 7, v3
  v_and_b32 v7, 3, v0
  v_lshl_add_u32 v3, v7, 3, v3
  s_lshl_b32 s61, s38, 5
  s_add_u32 s61, s61, 0
  v_add_u32 v3, s61, v3
  ds_read_b64_tr_b16 v[40:41], v3 offset:0
  ds_read_b64_tr_b16 v[42:43], v3 offset:512
  ds_read_b64_tr_b16 v[44:45], v3 offset:4096
  ds_read_b64_tr_b16 v[46:47], v3 offset:4608
  ds_read_b64_tr_b16 v[48:49], v3 offset:8192
  ds_read_b64_tr_b16 v[50:51], v3 offset:8704
  ds_read_b64_tr_b16 v[52:53], v3 offset:12288
  ds_read_b64_tr_b16 v[54:55], v3 offset:12800
  ds_read_b64_tr_b16 v[56:57], v3 offset:16384
  ds_read_b64_tr_b16 v[58:59], v3 offset:16896
  s_waitcnt lgkmcnt(4)
  ds_read_b64_tr_b16 v[60:61], v3 offset:20480
  ds_read_b64_tr_b16 v[62:63], v3 offset:20992
  ds_read_b64_tr_b16 v[64:65], v3 offset:24576
  ds_read_b64_tr_b16 v[66:67], v3 offset:25088
  ds_read_b64_tr_b16 v[68:69], v3 offset:28672
  ds_read_b64_tr_b16 v[70:71], v3 offset:29184
  ds_read_b64_tr_b16 v[72:73], v3 offset:32768
  ds_read_b64_tr_b16 v[74:75], v3 offset:33280
  ds_read_b64_tr_b16 v[76:77], v3 offset:36864
  ds_read_b64_tr_b16 v[78:79], v3 offset:37376
  s_waitcnt lgkmcnt(4)
  ds_read_b64_tr_b16 v[80:81], v3 offset:40960
  ds_read_b64_tr_b16 v[82:83], v3 offset:41472
  ds_read_b64_tr_b16 v[84:85], v3 offset:45056
  ds_read_b64_tr_b16 v[86:87], v3 offset:45568
  ds_read_b64_tr_b16 v[88:89], v3 offset:49152
  ds_read_b64_tr_b16 v[90:91], v3 offset:49664
  ds_read_b64_tr_b16 v[92:93], v3 offset:53248
  ds_read_b64_tr_b16 v[94:95], v3 offset:53760
  ds_read_b64_tr_b16 v[96:97], v3 offset:57344
  ds_read_b64_tr_b16 v[98:99], v3 offset:57856
  s_waitcnt lgkmcnt(4)
  ds_read_b64_tr_b16 v[100:101], v3 offset:61440
  ds_read_b64_tr_b16 v[102:103], v3 offset:61952
  s_waitcnt lgkmcnt(0)
  v_mov_b32 v38, 152960
  v_mov_b32 v39, 1
  s_mov_b64 exec, 1
  ds_add_u32 v38, v39
  s_mov_b64 exec, -1
  s_cmp_lg_u32 s38, 0
  s_cbranch_scc1 L_h0e_32
  s_waitcnt vmcnt(0)
  s_lshl_b32 s60, s36, 7
  s_lshl_b32 s61, s37, 2
  s_add_u32 s60, s60, s61
  s_add_u32 s60, s60, 2162688
  s_mov_b64 exec, 1
  s_xor_b32 s61, s81, s57
  v_mov_b32 v38, 0
  v_mov_b32 v39, s61
  buffer_store_dword v39, v38, s[40:43], s60 offen sc1
  s_mov_b64 exec, -1
L_h0e_32:
  s_cmp_lg_u32 s38, 0
  s_cbranch_scc1 L_h0e_33
  s_lshl_b32 s61, s37, 7
  s_mov_b32 s60, 0
  s_add_u32 s61, s61, s60
  s_add_u32 s61, s61, 2359300
  s_and_b32 s61, s37, 15
  s_lshl_b32 s61, s61, 7
  s_lshl_b32 s60, s36, 11
  s_add_u32 s61, s61, s60
  s_add_u32 s61, s61, 2113540
  v_mov_b32 v8, 0
  s_branch L_sn2_35
L_sn_34:
  s_sleep 24
L_sn2_35:
  buffer_load_dword v9, v8, s[40:43], s61 offen sc1
  s_waitcnt vmcnt(0)
  v_readfirstlane_b32 s82, v9
  s_add_u32 s80, s80, 1
  s_cmp_gt_u32 s80, 400000
  s_cbranch_scc1 L_abort
  s_cmp_eq_u32 s82, s81
  s_cbranch_scc0 L_sn_34
  s_lshl_b32 s60, s36, 11
  s_add_u32 s60, s60, 2113536
  v_lshlrev_b32 v6, 5, v0
  v_and_b32 v7, 31, v0
  v_lshlrev_b32 v7, 2, v7
  s_lshl_b32 s61, s36, 7
  s_add_u32 s61, s61, 2162688
L_qp_36:
  buffer_load_dwordx4 v[8:11], v6, s[40:43], s60 offen sc1
  buffer_load_dwordx4 v[12:15], v6, s[40:43], s60 offen offset:16 sc1
  buffer_load_dword v17, v7, s[40:43], s61 offen sc1
  s_waitcnt vmcnt(0)
  v_xor_b32 v9, s81, v9
  v_xor_b32 v11, s81, v11
  v_xor_b32 v13, s81, v13
  v_xor_b32 v15, s81, v15
  v_xor_b32 v17, s81, v17
  v_mov_b32 v18, v17
  v_lshrrev_b32 v17, 4, v17
  v_or3_b32 v16, v9, v11, v13
  v_or3_b32 v16, v16, v15, v17
  v_cmp_eq_u32 vcc, 0, v16
  s_add_u32 s80, s80, 1
  s_cmp_gt_u32 s80, 400000
  s_cbranch_scc1 L_abort
  s_cmp_eq_u64 vcc, exec
  s_cbranch_scc1 L_pk_37
  s_sleep 4
  s_branch L_qp_36
L_pk_37:
  v_cmp_eq_u32 vcc, s57, v18
  s_nop 0
  s_cmp_eq_u64 vcc, exec
  s_cselect_b32 s58, 1, 0
  v_mov_b32 v9, v10
  v_mov_b32 v10, v12
  v_mov_b32 v11, v14
  v_lshlrev_b32 v6, 4, v0
  v_add_u32 v6, 147712, v6
  ds_write_b128 v6, v[8:11]
  v_mov_b32 v12, 153064
  v_mov_b32 v13, s58
  s_mov_b64 exec, 1
  ds_write_b32 v12, v13
  s_mov_b64 exec, -1
  s_waitcnt lgkmcnt(0)
L_h0e_33:
  s_barrier
  v_mov_b32 v38, 153064
  ds_read_b32 v39, v38
  s_waitcnt lgkmcnt(0)
  v_readfirstlane_b32 s58, v39
  s_barrier
  s_cmp_lg_u32 s38, 0
  s_cbranch_scc1 L_h0e_38
  s_mov_b32 s78, s37
  v_lshlrev_b32 v6, 7, v2
  v_lshl_add_u32 v6, v1, 3, v6
  s_lshl_b32 s64, s36, 5
  s_add_u32 s64, s64, s78
  s_lshl_b32 s64, s64, 12
  s_add_u32 s65, s64, 5242880
  s_lshl_b32 s62, s36, 12
  s_lshl_b32 s61, s78, 7
  s_add_u32 s62, s62, s61
  s_add_u32 s63, s62, 2293760
  s_add_u32 s62, s62, 2228224
  s_cmp_eq_u32 s58, 0
  s_cbranch_scc1 L_asd_40
  v_lshlrev_b32 v28, 7, v0
  v_add_u32 v28, 4, v28
  s_mov_b32 s77, 0
  s_mov_b32 exec_hi, 0
L_as_39:
  buffer_load_dword v29, v28, s[40:43], s65 offen nt
  s_waitcnt vmcnt(0)
  v_cmp_ne_u32 vcc, 0, v29
  s_add_u32 s77, s77, 1
  s_bcnt1_i32_b64 s76, vcc
  s_cmp_ge_u32 s76, 28
  s_cbranch_scc1 L_asd_40
  s_cmp_gt_u32 s77, 400000
  s_cbranch_scc1 L_abort
  s_sleep 10
  s_branch L_as_39
L_asd_40:
  s_mov_b64 exec, -1
  s_cmp_eq_u32 s58, 0
  s_cbranch_scc1 L_tps_44
L_tpf_43:
  buffer_load_dwordx2 v[8:9], v6, s[40:43], s65 offen offset:0 nt
  buffer_load_dwordx2 v[10:11], v6, s[40:43], s65 offen offset:512 nt
  buffer_load_dwordx2 v[12:13], v6, s[40:43], s65 offen offset:1024 nt
  buffer_load_dwordx2 v[14:15], v6, s[40:43], s65 offen offset:1536 nt
  buffer_load_dwordx2 v[16:17], v6, s[40:43], s65 offen offset:2048 nt
  buffer_load_dwordx2 v[18:19], v6, s[40:43], s65 offen offset:2560 nt
  buffer_load_dwordx2 v[20:21], v6, s[40:43], s65 offen offset:3072 nt
  buffer_load_dwordx2 v[22:23], v6, s[40:43], s65 offen offset:3584 nt
  s_waitcnt vmcnt(0)
  v_min3_u32 v24, v8, v9, v10
  v_min3_u32 v24, v24, v11, v12
  v_min3_u32 v24, v24, v13, v14
  v_min3_u32 v24, v24, v15, v16
  v_min3_u32 v24, v24, v17, v18
  v_min3_u32 v24, v24, v19, v20
  v_min3_u32 v24, v24, v21, v22
  v_min_u32 v24, v24, v23
  v_cmp_ne_u32 vcc, 0, v24
  s_add_u32 s80, s80, 1
  s_cmp_gt_u32 s80, 400000
  s_cbranch_scc1 L_abort
  s_cmp_eq_u64 vcc, exec
  s_cbranch_scc0 L_tpf_43
  s_branch L_tpd_42
L_tps_44:
  s_lshl_b32 s76, s36, 3
  s_lshr_b32 s77, s78, 2
  s_add_u32 s76, s76, s77
  s_lshl_b32 s76, s76, 7
  s_add_u32 s76, s76, 2170880
  v_and_b32 v28, 31, v0
  v_lshlrev_b32 v28, 2, v28
L_fa_46:
  buffer_load_dword v29, v28, s[40:43], s76 offen sc1
  s_waitcnt vmcnt(0)
  v_cmp_eq_u32 vcc, s81, v29
  s_add_u32 s80, s80, 1
  s_cmp_gt_u32 s80, 400000
  s_cbranch_scc1 L_abort
  s_cmp_eq_u64 vcc, exec
  s_cbranch_scc0 L_fa_46
L_tps2_45:
  buffer_load_dwordx2 v[8:9], v6, s[40:43], s64 offen offset:0 sc1
  buffer_load_dwordx2 v[10:11], v6, s[40:43], s64 offen offset:512 sc1
  buffer_load_dwordx2 v[12:13], v6, s[40:43], s64 offen offset:1024 sc1
  buffer_load_dwordx2 v[14:15], v6, s[40:43], s64 offen offset:1536 sc1
  buffer_load_dwordx2 v[16:17], v6, s[40:43], s64 offen offset:2048 sc1
  buffer_load_dwordx2 v[18:19], v6, s[40:43], s64 offen offset:2560 sc1
  buffer_load_dwordx2 v[20:21], v6, s[40:43], s64 offen offset:3072 sc1
  buffer_load_dwordx2 v[22:23], v6, s[40:43], s64 offen offset:3584 sc1
  s_waitcnt vmcnt(0)
  v_min3_u32 v24, v8, v9, v10
  v_min3_u32 v24, v24, v11, v12
  v_min3_u32 v24, v24, v13, v14
  v_min3_u32 v24, v24, v15, v16
  v_min3_u32 v24, v24, v17, v18
  v_min3_u32 v24, v24, v19, v20
  v_min3_u32 v24, v24, v21, v22
  v_min_u32 v24, v24, v23
  v_cmp_ne_u32 vcc, 0, v24
  s_add_u32 s80, s80, 1
  s_cmp_gt_u32 s80, 400000
  s_cbranch_scc1 L_abort
  s_cmp_eq_u64 vcc, exec
  s_cbranch_scc0 L_tps2_45
L_tpd_42:
  v_max3_f32 v24, v9, v11, v13
  v_max3_f32 v24, v24, v15, v17
  v_max3_f32 v24, v24, v19, v21
  v_max_f32 v24, v24, v23
  v_mov_b32 v26, v24
  s_nop 1
  v_permlane16_swap_b32 v24, v26
  v_max_f32 v24, v24, v26
  v_mov_b32 v26, v24
  s_nop 1
  v_permlane32_swap_b32 v24, v26
  v_max_f32 v24, v24, v26
  v_sub_f32 v9, v9, v24
  v_sub_f32 v11, v11, v24
  v_sub_f32 v13, v13, v24
  v_sub_f32 v15, v15, v24
  v_sub_f32 v17, v17, v24
  v_sub_f32 v19, v19, v24
  v_sub_f32 v21, v21, v24
  v_sub_f32 v23, v23, v24
  v_exp_f32 v9, v9
  v_exp_f32 v11, v11
  v_exp_f32 v13, v13
  v_exp_f32 v15, v15
  v_exp_f32 v17, v17
  v_exp_f32 v19, v19
  v_exp_f32 v21, v21
  v_exp_f32 v23, v23
  v_mul_f32 v24, v9, v8
  v_mov_b32 v25, v9
  v_fmac_f32 v24, v11, v10
  v_add_f32 v25, v25, v11
  v_fmac_f32 v24, v13, v12
  v_add_f32 v25, v25, v13
  v_fmac_f32 v24, v15, v14
  v_add_f32 v25, v25, v15
  v_fmac_f32 v24, v17, v16
  v_add_f32 v25, v25, v17
  v_fmac_f32 v24, v19, v18
  v_add_f32 v25, v25, v19
  v_fmac_f32 v24, v21, v20
  v_add_f32 v25, v25, v21
  v_fmac_f32 v24, v23, v22
  v_add_f32 v25, v25, v23
  v_mov_b32 v26, v24
  v_mov_b32 v27, v25
  s_nop 0
  v_permlane16_swap_b32 v24, v26
  v_permlane16_swap_b32 v25, v27
  v_add_f32 v24, v24, v26
  v_add_f32 v25, v25, v27
  v_mov_b32 v26, v24
  v_mov_b32 v27, v25
  s_nop 0
  v_permlane32_swap_b32 v24, v26
  v_permlane32_swap_b32 v25, v27
  v_add_f32 v24, v24, v26
  v_add_f32 v25, v25, v27
  v_rcp_f32 v25, v25
  v_lshlrev_b32 v6, 3, v1
  v_mul_f32 v24, v24, v25
  v_mov_b32 v25, s81
  s_mov_b64 exec, 0xffff
  s_cmp_eq_u32 s58, 0
  s_cbranch_scc1 L_tb_47
  buffer_store_dwordx2 v[24:25], v6, s[40:43], s63 offen
  s_branch L_tb2_48
L_tb_47:
  buffer_store_dwordx2 v[24:25], v6, s[40:43], s62 offen sc1
L_tb2_48:
  s_mov_b64 exec, -1
  v_lshlrev_b32 v6, 6, v0
  s_lshl_b32 s64, s36, 12
  s_add_u32 s65, s64, 2293760
  s_add_u32 s64, s64, 2228224
  s_cmp_eq_u32 s58, 0
  s_cbranch_scc1 L_tps_51
L_tpf_50:
  buffer_load_dwordx4 v[8:11], v6, s[40:43], s65 offen offset:0 nt
  buffer_load_dwordx4 v[12:15], v6, s[40:43], s65 offen offset:16 nt
  buffer_load_dwordx4 v[16:19], v6, s[40:43], s65 offen offset:32 nt
  buffer_load_dwordx4 v[20:23], v6, s[40:43], s65 offen offset:48 nt
  s_waitcnt vmcnt(0)
  v_xor_b32 v9, s81, v9
  v_xor_b32 v11, s81, v11
  v_xor_b32 v13, s81, v13
  v_xor_b32 v15, s81, v15
  v_xor_b32 v17, s81, v17
  v_xor_b32 v19, s81, v19
  v_xor_b32 v21, s81, v21
  v_xor_b32 v23, s81, v23
  v_or3_b32 v24, v9, v11, v13
  v_or3_b32 v24, v24, v15, v17
  v_or3_b32 v24, v24, v19, v21
  v_or_b32 v24, v24, v23
  v_cmp_eq_u32 vcc, 0, v24
  s_add_u32 s80, s80, 1
  s_cmp_gt_u32 s80, 400000
  s_cbranch_scc1 L_abort
  s_cmp_eq_u64 vcc, exec
  s_cbranch_scc0 L_tpf_50
  s_branch L_tpd_49
L_tps_51:
L_tps2_52:
  buffer_load_dwordx4 v[8:11], v6, s[40:43], s64 offen offset:0 sc1
  buffer_load_dwordx4 v[12:15], v6, s[40:43], s64 offen offset:16 sc1
  buffer_load_dwordx4 v[16:19], v6, s[40:43], s64 offen offset:32 sc1
  buffer_load_dwordx4 v[20:23], v6, s[40:43], s64 offen offset:48 sc1
  s_waitcnt vmcnt(0)
  v_xor_b32 v9, s81, v9
  v_xor_b32 v11, s81, v11
  v_xor_b32 v13, s81, v13
  v_xor_b32 v15, s81, v15
  v_xor_b32 v17, s81, v17
  v_xor_b32 v19, s81, v19
  v_xor_b32 v21, s81, v21
  v_xor_b32 v23, s81, v23
  v_or3_b32 v24, v9, v11, v13
  v_or3_b32 v24, v24, v15, v17
  v_or3_b32 v24, v24, v19, v21
  v_or_b32 v24, v24, v23
  v_cmp_eq_u32 vcc, 0, v24
  s_add_u32 s80, s80, 1
  s_cmp_gt_u32 s80, 400000
  s_cbranch_scc1 L_abort
  s_cmp_eq_u64 vcc, exec
  s_cbranch_scc0 L_tps2_52
L_tpd_49:
  v_cvt_pk_bf16_f32 v24, v8, v10
  v_cvt_pk_bf16_f32 v25, v12, v14
  v_cvt_pk_bf16_f32 v26, v16, v18
  v_cvt_pk_bf16_f32 v27, v20, v22
  v_lshlrev_b32 v6, 4, v0
  v_add_u32 v6, 148736, v6
  ds_write_b128 v6, v[24:27]
  s_waitcnt lgkmcnt(0)
L_h0e_38:
  v_lshlrev_b32 v4, 4, v2
  v_add_u32 v4, 148736, v4
  s_lshl_b32 s60, s36, 11
  s_sub_u32 s61, s37, 8
  s_lshl_b32 s61, s61, 8
  s_add_u32 s60, s60, s61
  s_lshl_b32 s61, s38, 6
  s_add_u32 s60, s60, s61
  s_add_u32 s60, s60, 1310720
  s_add_u32 s61, s60, 65536
  v_lshlrev_b32 v7, 14, v2
  v_lshl_add_u32 v7, v1, 2, v7
  s_barrier
  ds_read_b128 v[8:11], v4 offset:0
  ds_read_b128 v[12:15], v4 offset:64
  ds_read_b128 v[16:19], v4 offset:128
  ds_read_b128 v[20:23], v4 offset:192
  ds_read_b128 v[24:27], v4 offset:256
  ds_read_b128 v[28:31], v4 offset:320
  ds_read_b128 v[32:35], v4 offset:384
  ds_read_b128 v[36:39], v4 offset:448
  s_waitcnt lgkmcnt(7)
  v_mfma_f32_16x16x32_bf16 v[104:107], v[8:11], v[40:43], 0
  ds_read_b128 v[8:11], v4 offset:512
  s_waitcnt lgkmcnt(7)
  v_mfma_f32_16x16x32_bf16 v[108:111], v[12:15], v[44:47], 0
  ds_read_b128 v[12:15], v4 offset:576
  s_waitcnt lgkmcnt(7)
  v_mfma_f32_16x16x32_bf16 v[104:107], v[16:19], v[48:51], v[104:107]
  ds_read_b128 v[16:19], v4 offset:640
  s_waitcnt lgkmcnt(7)
  v_mfma_f32_16x16x32_bf16 v[108:111], v[20:23], v[52:55], v[108:111]
  ds_read_b128 v[20:23], v4 offset:704
  s_waitcnt lgkmcnt(7)
  v_mfma_f32_16x16x32_bf16 v[104:107], v[24:27], v[56:59], v[104:107]
  ds_read_b128 v[24:27], v4 offset:768
  s_waitcnt lgkmcnt(7)
  v_mfma_f32_16x16x32_bf16 v[108:111], v[28:31], v[60:63], v[108:111]
  ds_read_b128 v[28:31], v4 offset:832
  s_waitcnt lgkmcnt(7)
  v_mfma_f32_16x16x32_bf16 v[104:107], v[32:35], v[64:67], v[104:107]
  ds_read_b128 v[32:35], v4 offset:896
  s_waitcnt lgkmcnt(7)
  v_mfma_f32_16x16x32_bf16 v[108:111], v[36:39], v[68:71], v[108:111]
  ds_read_b128 v[36:39], v4 offset:960
  s_waitcnt lgkmcnt(7)
  v_mfma_f32_16x16x32_bf16 v[104:107], v[8:11], v[72:75], v[104:107]
  s_waitcnt lgkmcnt(6)
  v_mfma_f32_16x16x32_bf16 v[108:111], v[12:15], v[76:79], v[108:111]
  s_waitcnt lgkmcnt(5)
  v_mfma_f32_16x16x32_bf16 v[104:107], v[16:19], v[80:83], v[104:107]
  s_waitcnt lgkmcnt(4)
  v_mfma_f32_16x16x32_bf16 v[108:111], v[20:23], v[84:87], v[108:111]
  s_waitcnt lgkmcnt(3)
  v_mfma_f32_16x16x32_bf16 v[104:107], v[24:27], v[88:91], v[104:107]
  s_waitcnt lgkmcnt(2)
  v_mfma_f32_16x16x32_bf16 v[108:111], v[28:31], v[92:95], v[108:111]
  s_waitcnt lgkmcnt(1)
  v_mfma_f32_16x16x32_bf16 v[104:107], v[32:35], v[96:99], v[104:107]
  s_waitcnt lgkmcnt(0)
  v_mfma_f32_16x16x32_bf16 v[108:111], v[36:39], v[100:103], v[108:111]
  s_nop 7
  v_add_f32 v104, v104, v108
  v_or_b32 v104, 1, v104
  s_nop 1
  v_mov_b32_dpp v8, v104 quad_perm:[0,0,0,0] row_mask:0xf bank_mask:0xf
  v_mov_b32_dpp v9, v104 quad_perm:[1,1,1,1] row_mask:0xf bank_mask:0xf
  v_mov_b32_dpp v10, v104 quad_perm:[2,2,2,2] row_mask:0xf bank_mask:0xf
  v_mov_b32_dpp v11, v104 quad_perm:[3,3,3,3] row_mask:0xf bank_mask:0xf
  s_mov_b32 exec_lo, 0x11111111
  s_mov_b32 exec_hi, 0x0
  buffer_store_dwordx4 v[8:11], v7, s[40:43], s60 offen sc1
  s_branch L_hend
L_role_mod:
  s_mul_i32 s62, s36, 768
  s_sub_u32 s61, s37, 16
  s_lshl_b32 s61, s61, 7
  s_add_u32 s62, s62, s61
  s_lshr_b32 s68, s62, 1
  s_lshl_b32 s61, s38, 4
  s_add_u32 s68, s68, s61
  s_mov_b32 s48, s28
  s_and_b32 s49, s29, 0xffff
  s_mov_b32 s50, 3145728
  s_mov_b32 s51, 0x00020000
  v_lshrrev_b32 v158, 3, v0
  s_mov_b32 s61, 6144
  v_mul_lo_u32 v158, v158, s61
  v_and_b32 v7, 7, v0
  v_lshl_add_u32 v158, v7, 4, v158
  s_mul_i32 s61, s38, 786432
  s_add_u32 s72, s62, s61
  s_lshl_b32 s66, s38, 14
  s_add_u32 s66, s66, 0
  s_mov_b32 s52, s26
  s_and_b32 s53, s27, 0xffff
  s_mov_b32 s54, 1024
  s_mov_b32 s55, 0x00020000
  v_lshlrev_b32 v7, 4, v0
  buffer_load_dwordx4 v[12:15], v7, s[52:55], 0 offen
  s_add_u32 m0, s66, 0
  s_nop 0
  buffer_load_dwordx4 v158, s[48:51], s72 offen nt lds
  s_add_u32 s72, s72, 49152
  s_add_u32 m0, s66, 1024
  s_nop 0
  buffer_load_dwordx4 v158, s[48:51], s72 offen nt lds
  s_add_u32 s72, s72, 49152
  s_add_u32 m0, s66, 2048
  s_nop 0
  buffer_load_dwordx4 v158, s[48:51], s72 offen nt lds
  s_add_u32 s72, s72, 49152
  s_add_u32 m0, s66, 3072
  s_nop 0
  buffer_load_dwordx4 v158, s[48:51], s72 offen nt lds
  s_add_u32 s72, s72, 49152
  s_add_u32 m0, s66, 4096
  s_nop 0
  buffer_load_dwordx4 v158, s[48:51], s72 offen nt lds
  s_add_u32 s72, s72, 49152
  s_add_u32 m0, s66, 5120
  s_nop 0
  buffer_load_dwordx4 v158, s[48:51], s72 offen nt lds
  s_add_u32 s72, s72, 49152
  s_add_u32 m0, s66, 6144
  s_nop 0
  buffer_load_dwordx4 v158, s[48:51], s72 offen nt lds
  s_add_u32 s72, s72, 49152
  s_add_u32 m0, s66, 7168
  s_nop 0
  buffer_load_dwordx4 v158, s[48:51], s72 offen nt lds
  s_add_u32 s72, s72, 49152
  s_add_u32 m0, s66, 8192
  s_nop 0
  buffer_load_dwordx4 v158, s[48:51], s72 offen nt lds
  s_add_u32 s72, s72, 49152
  s_add_u32 m0, s66, 9216
  s_nop 0
  buffer_load_dwordx4 v158, s[48:51], s72 offen nt lds
  s_add_u32 s72, s72, 49152
  s_add_u32 m0, s66, 10240
  s_nop 0
  buffer_load_dwordx4 v158, s[48:51], s72 offen nt lds
  s_add_u32 s72, s72, 49152
  s_add_u32 m0, s66, 11264
  s_nop 0
  buffer_load_dwordx4 v158, s[48:51], s72 offen nt lds
  s_add_u32 s72, s72, 49152
  s_add_u32 m0, s66, 12288
  s_nop 0
  buffer_load_dwordx4 v158, s[48:51], s72 offen nt lds
  s_add_u32 s72, s72, 49152
  s_add_u32 m0, s66, 13312
  s_nop 0
  buffer_load_dwordx4 v158, s[48:51], s72 offen nt lds
  s_add_u32 s72, s72, 49152
  s_add_u32 m0, s66, 14336
  s_nop 0
  buffer_load_dwordx4 v158, s[48:51], s72 offen nt lds
  s_add_u32 s72, s72, 49152
  s_add_u32 m0, s66, 15360
  s_nop 0
  buffer_load_dwordx4 v158, s[48:51], s72 offen nt lds
  s_waitcnt lgkmcnt(0)
  s_barrier
  s_waitcnt vmcnt(0)
  v_mov_b32 v38, 152960
  v_mov_b32 v39, 1
  s_mov_b64 exec, 1
  ds_add_u32 v38, v39
  s_mov_b64 exec, -1
L_ls_53:
  ds_read_b32 v39, v38
  s_waitcnt lgkmcnt(0)
  v_readfirstlane_b32 s82, v39
  s_add_u32 s80, s80, 1
  s_cmp_gt_u32 s80, 400000
  s_cbranch_scc1 L_abort
  s_cmp_lt_u32 s82, 4
  s_cbranch_scc1 L_ls_53
  v_lshrrev_b32 v3, 2, v1
  v_lshl_add_u32 v3, v2, 3, v3
  v_lshlrev_b32 v3, 7, v3
  v_and_b32 v7, 3, v0
  v_lshl_add_u32 v3, v7, 3, v3
  s_lshl_b32 s61, s38, 5
  s_add_u32 s61, s61, 0
  v_add_u32 v3, s61, v3
  ds_read_b64_tr_b16 v[40:41], v3 offset:0
  ds_read_b64_tr_b16 v[42:43], v3 offset:512
  ds_read_b64_tr_b16 v[44:45], v3 offset:4096
  ds_read_b64_tr_b16 v[46:47], v3 offset:4608
  ds_read_b64_tr_b16 v[48:49], v3 offset:8192
  ds_read_b64_tr_b16 v[50:51], v3 offset:8704
  ds_read_b64_tr_b16 v[52:53], v3 offset:12288
  ds_read_b64_tr_b16 v[54:55], v3 offset:12800
  ds_read_b64_tr_b16 v[56:57], v3 offset:16384
  ds_read_b64_tr_b16 v[58:59], v3 offset:16896
  s_waitcnt lgkmcnt(4)
  ds_read_b64_tr_b16 v[60:61], v3 offset:20480
  ds_read_b64_tr_b16 v[62:63], v3 offset:20992
  ds_read_b64_tr_b16 v[64:65], v3 offset:24576
  ds_read_b64_tr_b16 v[66:67], v3 offset:25088
  ds_read_b64_tr_b16 v[68:69], v3 offset:28672
  ds_read_b64_tr_b16 v[70:71], v3 offset:29184
  ds_read_b64_tr_b16 v[72:73], v3 offset:32768
  ds_read_b64_tr_b16 v[74:75], v3 offset:33280
  ds_read_b64_tr_b16 v[76:77], v3 offset:36864
  ds_read_b64_tr_b16 v[78:79], v3 offset:37376
  s_waitcnt lgkmcnt(4)
  ds_read_b64_tr_b16 v[80:81], v3 offset:40960
  ds_read_b64_tr_b16 v[82:83], v3 offset:41472
  ds_read_b64_tr_b16 v[84:85], v3 offset:45056
  ds_read_b64_tr_b16 v[86:87], v3 offset:45568
  ds_read_b64_tr_b16 v[88:89], v3 offset:49152
  ds_read_b64_tr_b16 v[90:91], v3 offset:49664
  ds_read_b64_tr_b16 v[92:93], v3 offset:53248
  ds_read_b64_tr_b16 v[94:95], v3 offset:53760
  ds_read_b64_tr_b16 v[96:97], v3 offset:57344
  ds_read_b64_tr_b16 v[98:99], v3 offset:57856
  s_waitcnt lgkmcnt(4)
  ds_read_b64_tr_b16 v[100:101], v3 offset:61440
  ds_read_b64_tr_b16 v[102:103], v3 offset:61952
  s_waitcnt lgkmcnt(0)
  v_mov_b32 v38, 152960
  v_mov_b32 v39, 1
  s_mov_b64 exec, 1
  ds_add_u32 v38, v39
  s_mov_b64 exec, -1
  s_cmp_lg_u32 s38, 0
  s_cbranch_scc1 L_h0e_55
  v_mov_b32 v8, 0
  v_mov_b32 v9, 0
  v_mov_b32 v10, 0
  v_mov_b32 v11, 0
  v_lshlrev_b32 v6, 4, v0
  s_lshl_b32 s60, s36, 5
  s_add_u32 s60, s60, s37
  s_lshl_b32 s60, s60, 12
  s_add_u32 s60, s60, 5242880
  buffer_store_dwordx4 v[8:11], v6, s[40:43], s60 offen offset:0
  buffer_store_dwordx4 v[8:11], v6, s[40:43], s60 offen offset:1024
  buffer_store_dwordx4 v[8:11], v6, s[40:43], s60 offen offset:2048
  buffer_store_dwordx4 v[8:11], v6, s[40:43], s60 offen offset:3072
  s_mov_b64 exec, -1
L_h0e_55:
  s_waitcnt lgkmcnt(0)
  s_mul_i32 s81, s83, 0x9E3779B1
  s_add_u32 s81, s81, 0x7F4A7C15
  v_lshlrev_b32 v16, 16, v12
  v_and_b32 v17, 0xffff0000, v12
  v_lshlrev_b32 v18, 16, v13
  v_and_b32 v19, 0xffff0000, v13
  v_lshlrev_b32 v20, 16, v14
  v_and_b32 v21, 0xffff0000, v14
  v_lshlrev_b32 v22, 16, v15
  v_and_b32 v23, 0xffff0000, v15
  s_mov_b32 s61, 0xbfb8aa3b
  v_mul_f32 v24, s61, v16
  v_mul_f32 v25, s61, v17
  v_mul_f32 v26, s61, v18
  v_mul_f32 v27, s61, v19
  v_mul_f32 v28, s61, v20
  v_mul_f32 v29, s61, v21
  v_mul_f32 v30, s61, v22
  v_mul_f32 v31, s61, v23
  s_mov_b32 s62, 0x42fc0000
  v_min_f32 v24, s62, v24
  v_min_f32 v25, s62, v25
  v_min_f32 v26, s62, v26
  v_min_f32 v27, s62, v27
  v_min_f32 v28, s62, v28
  v_min_f32 v29, s62, v29
  v_min_f32 v30, s62, v30
  v_min_f32 v31, s62, v31
  v_exp_f32 v24, v24
  v_exp_f32 v25, v25
  v_exp_f32 v26, v26
  v_exp_f32 v27, v27
  v_exp_f32 v28, v28
  v_exp_f32 v29, v29
  v_exp_f32 v30, v30
  v_exp_f32 v31, v31
  v_add_f32 v24, 1.0, v24
  v_add_f32 v25, 1.0, v25
  v_add_f32 v26, 1.0, v26
  v_add_f32 v27, 1.0, v27
  v_add_f32 v28, 1.0, v28
  v_add_f32 v29, 1.0, v29
  v_add_f32 v30, 1.0, v30
  v_add_f32 v31, 1.0, v31
  v_rcp_f32 v32, v24
  v_rcp_f32 v33, v25
  v_rcp_f32 v34, v26
  v_rcp_f32 v35, v27
  v_rcp_f32 v36, v28
  v_rcp_f32 v37, v29
  v_rcp_f32 v38, v30
  v_rcp_f32 v39, v31
  v_fma_f32 v24, -v24, v32, 1.0
  v_fma_f32 v25, -v25, v33, 1.0
  v_fma_f32 v26, -v26, v34, 1.0
  v_fma_f32 v27, -v27, v35, 1.0
  v_fma_f32 v28, -v28, v36, 1.0
  v_fma_f32 v29, -v29, v37, 1.0
  v_fma_f32 v30, -v30, v38, 1.0
  v_fma_f32 v31, -v31, v39, 1.0
  v_fma_f32 v24, v24, v32, v32
  v_fma_f32 v25, v25, v33, v33
  v_fma_f32 v26, v26, v34, v34
  v_fma_f32 v27, v27, v35, v35
  v_fma_f32 v28, v28, v36, v36
  v_fma_f32 v29, v29, v37, v37
  v_fma_f32 v30, v30, v38, v38
  v_fma_f32 v31, v31, v39, v39
  v_mul_f32 v16, v16, v24
  v_mul_f32 v17, v17, v25
  v_mul_f32 v18, v18, v26
  v_mul_f32 v19, v19, v27
  v_mul_f32 v20, v20, v28
  v_mul_f32 v21, v21, v29
  v_mul_f32 v22, v22, v30
  v_mul_f32 v23, v23, v31
  v_cvt_pk_bf16_f32 v8, v16, v17
  v_cvt_pk_bf16_f32 v9, v18, v19
  v_cvt_pk_bf16_f32 v10, v20, v21
  v_cvt_pk_bf16_f32 v11, v22, v23
  ds_write_b128 v5, v[8:11]
  s_waitcnt lgkmcnt(0)
  ds_read_b128 v[8:11], v4 offset:0
  ds_read_b128 v[12:15], v4 offset:64
  ds_read_b128 v[16:19], v4 offset:128
  ds_read_b128 v[20:23], v4 offset:192
  ds_read_b128 v[24:27], v4 offset:256
  ds_read_b128 v[28:31], v4 offset:320
  ds_read_b128 v[32:35], v4 offset:384
  ds_read_b128 v[36:39], v4 offset:448
  s_waitcnt lgkmcnt(7)
  v_mfma_f32_16x16x32_bf16 v[104:107], v[8:11], v[40:43], 0
  ds_read_b128 v[8:11], v4 offset:512
  s_waitcnt lgkmcnt(7)
  v_mfma_f32_16x16x32_bf16 v[108:111], v[12:15], v[44:47], 0
  ds_read_b128 v[12:15], v4 offset:576
  s_waitcnt lgkmcnt(7)
  v_mfma_f32_16x16x32_bf16 v[104:107], v[16:19], v[48:51], v[104:107]
  ds_read_b128 v[16:19], v4 offset:640
  s_waitcnt lgkmcnt(7)
  v_mfma_f32_16x16x32_bf16 v[108:111], v[20:23], v[52:55], v[108:111]
  ds_read_b128 v[20:23], v4 offset:704
  s_waitcnt lgkmcnt(7)
  v_mfma_f32_16x16x32_bf16 v[104:107], v[24:27], v[56:59], v[104:107]
  ds_read_b128 v[24:27], v4 offset:768
  s_waitcnt lgkmcnt(7)
  v_mfma_f32_16x16x32_bf16 v[108:111], v[28:31], v[60:63], v[108:111]
  ds_read_b128 v[28:31], v4 offset:832
  s_waitcnt lgkmcnt(7)
  v_mfma_f32_16x16x32_bf16 v[104:107], v[32:35], v[64:67], v[104:107]
  ds_read_b128 v[32:35], v4 offset:896
  s_waitcnt lgkmcnt(7)
  v_mfma_f32_16x16x32_bf16 v[108:111], v[36:39], v[68:71], v[108:111]
  ds_read_b128 v[36:39], v4 offset:960
  s_waitcnt lgkmcnt(7)
  v_mfma_f32_16x16x32_bf16 v[104:107], v[8:11], v[72:75], v[104:107]
  s_waitcnt lgkmcnt(6)
  v_mfma_f32_16x16x32_bf16 v[108:111], v[12:15], v[76:79], v[108:111]
  s_waitcnt lgkmcnt(5)
  v_mfma_f32_16x16x32_bf16 v[104:107], v[16:19], v[80:83], v[104:107]
  s_waitcnt lgkmcnt(4)
  v_mfma_f32_16x16x32_bf16 v[108:111], v[20:23], v[84:87], v[108:111]
  s_waitcnt lgkmcnt(3)
  v_mfma_f32_16x16x32_bf16 v[104:107], v[24:27], v[88:91], v[104:107]
  s_waitcnt lgkmcnt(2)
  v_mfma_f32_16x16x32_bf16 v[108:111], v[28:31], v[92:95], v[108:111]
  s_waitcnt lgkmcnt(1)
  v_mfma_f32_16x16x32_bf16 v[104:107], v[32:35], v[96:99], v[104:107]
  s_waitcnt lgkmcnt(0)
  v_mfma_f32_16x16x32_bf16 v[108:111], v[36:39], v[100:103], v[108:111]
  s_nop 7
  v_add_f32 v104, v104, v108
  s_lshl_b32 s60, s68, 2
  s_add_u32 s60, s60, 2359296
  s_add_u32 s61, s60, 65536
  v_mov_b32_dpp v105, v104 quad_perm:[1,1,3,3] row_mask:0xf bank_mask:0xf
  v_cvt_pk_bf16_f32 v104, v104, v105
  v_mov_b32 v105, s81
  v_lshlrev_b32 v6, 14, v2
  v_lshl_add_u32 v6, v1, 2, v6
  s_mov_b32 exec_lo, 0x5555
  s_mov_b32 exec_hi, 0x0
  buffer_store_dwordx2 v[104:105], v6, s[40:43], s60 offen sc1
  s_mov_b64 exec, -1
  s_cmp_lg_u32 s38, 0
  s_cbranch_scc1 L_h0e_56
  s_waitcnt vmcnt(0)
  s_lshl_b32 s60, s36, 7
  s_lshl_b32 s61, s37, 2
  s_add_u32 s60, s60, s61
  s_add_u32 s60, s60, 2162688
  s_mov_b64 exec, 1
  s_xor_b32 s61, s81, s57
  v_mov_b32 v38, 0
  v_mov_b32 v39, s61
  buffer_store_dword v39, v38, s[40:43], s60 offen sc1
  s_mov_b64 exec, -1
L_h0e_56:
  s_cmp_lg_u32 s38, 0
  s_cbranch_scc1 L_h0e_57
  s_lshl_b32 s61, s37, 7
  s_mov_b32 s60, 0
  s_add_u32 s61, s61, s60
  s_add_u32 s61, s61, 2359300
  s_and_b32 s61, s37, 15
  s_lshl_b32 s61, s61, 7
  s_lshl_b32 s60, s36, 11
  s_add_u32 s61, s61, s60
  s_add_u32 s61, s61, 2113540
  v_mov_b32 v8, 0
  s_branch L_sn2_59
L_sn_58:
  s_sleep 24
L_sn2_59:
  buffer_load_dword v9, v8, s[40:43], s61 offen sc1
  s_waitcnt vmcnt(0)
  v_readfirstlane_b32 s82, v9
  s_add_u32 s80, s80, 1
  s_cmp_gt_u32 s80, 400000
  s_cbranch_scc1 L_abort
  s_cmp_eq_u32 s82, s81
  s_cbranch_scc0 L_sn_58
  s_lshl_b32 s60, s36, 11
  s_add_u32 s60, s60, 2113536
  v_lshlrev_b32 v6, 5, v0
  v_and_b32 v7, 31, v0
  v_lshlrev_b32 v7, 2, v7
  s_lshl_b32 s61, s36, 7
  s_add_u32 s61, s61, 2162688
L_qp_60:
  buffer_load_dwordx4 v[8:11], v6, s[40:43], s60 offen sc1
  buffer_load_dwordx4 v[12:15], v6, s[40:43], s60 offen offset:16 sc1
  buffer_load_dword v17, v7, s[40:43], s61 offen sc1
  s_waitcnt vmcnt(0)
  v_xor_b32 v9, s81, v9
  v_xor_b32 v11, s81, v11
  v_xor_b32 v13, s81, v13
  v_xor_b32 v15, s81, v15
  v_xor_b32 v17, s81, v17
  v_mov_b32 v18, v17
  v_lshrrev_b32 v17, 4, v17
  v_or3_b32 v16, v9, v11, v13
  v_or3_b32 v16, v16, v15, v17
  v_cmp_eq_u32 vcc, 0, v16
  s_add_u32 s80, s80, 1
  s_cmp_gt_u32 s80, 400000
  s_cbranch_scc1 L_abort
  s_cmp_eq_u64 vcc, exec
  s_cbranch_scc1 L_pk_61
  s_sleep 4
  s_branch L_qp_60
L_pk_61:
  v_cmp_eq_u32 vcc, s57, v18
  s_nop 0
  s_cmp_eq_u64 vcc, exec
  s_cselect_b32 s58, 1, 0
  v_mov_b32 v9, v10
  v_mov_b32 v10, v12
  v_mov_b32 v11, v14
  v_lshlrev_b32 v6, 4, v0
  v_add_u32 v6, 147712, v6
  ds_write_b128 v6, v[8:11]
  v_mov_b32 v12, 153064
  v_mov_b32 v13, s58
  s_mov_b64 exec, 1
  ds_write_b32 v12, v13
  s_mov_b64 exec, -1
  s_waitcnt lgkmcnt(0)
L_h0e_57:
  s_barrier
  v_mov_b32 v38, 153064
  ds_read_b32 v39, v38
  s_waitcnt lgkmcnt(0)
  v_readfirstlane_b32 s58, v39
  s_mov_b32 s75, 3
  s_cmp_eq_u32 s37, 21
  s_cbranch_scc1 L_fin_common
  s_branch L_tail_plain
L_role_fin:
  s_cmp_eq_u32 s38, 0
  s_cbranch_scc1 L_nocpf_62
  s_getpc_b64 s[60:61]
L_pc_here:
  s_sub_u32 s60, s60, L_pc_here-adaLN_cond__gqa_block_cached__swiglu_ffn__decode_kernel
  s_subb_u32 s61, s61, 0
  s_sub_u32 s62, s38, 1
  s_lshl_b32 s62, s62, 12
  v_lshlrev_b32 v6, 6, v0
L_cpf_63:
  v_add_u32 v7, s62, v6
  v_min_u32 v7, L_code_end-adaLN_cond__gqa_block_cached__swiglu_ffn__decode_kernel-4, v7
  global_load_dword v8, v7, s[60:61]
  s_add_u32 s62, s62, 12288
  s_cmp_lt_u32 s62, L_code_end-adaLN_cond__gqa_block_cached__swiglu_ffn__decode_kernel
  s_cbranch_scc1 L_cpf_63
L_nocpf_62:
  s_waitcnt lgkmcnt(0)
  s_barrier
  s_cmp_lg_u32 s38, 0
  s_cbranch_scc1 L_h0e_64
  v_mov_b32 v8, 0
  v_mov_b32 v9, 0
  v_mov_b32 v10, 0
  v_mov_b32 v11, 0
  v_lshlrev_b32 v6, 4, v0
  s_lshl_b32 s60, s36, 5
  s_add_u32 s60, s60, s37
  s_lshl_b32 s60, s60, 12
  s_add_u32 s60, s60, 5242880
  buffer_store_dwordx4 v[8:11], v6, s[40:43], s60 offen offset:0
  buffer_store_dwordx4 v[8:11], v6, s[40:43], s60 offen offset:1024
  buffer_store_dwordx4 v[8:11], v6, s[40:43], s60 offen offset:2048
  buffer_store_dwordx4 v[8:11], v6, s[40:43], s60 offen offset:3072
  s_mov_b64 exec, -1
L_h0e_64:
  s_waitcnt lgkmcnt(0)
  s_mul_i32 s81, s83, 0x9E3779B1
  s_add_u32 s81, s81, 0x7F4A7C15
  s_cmp_lg_u32 s38, 0
  s_cbranch_scc1 L_h0e_65
  s_waitcnt vmcnt(0)
  s_lshl_b32 s60, s36, 7
  s_lshl_b32 s61, s37, 2
  s_add_u32 s60, s60, s61
  s_add_u32 s60, s60, 2162688
  s_mov_b64 exec, 1
  s_xor_b32 s61, s81, s57
  v_mov_b32 v38, 0
  v_mov_b32 v39, s61
  buffer_store_dword v39, v38, s[40:43], s60 offen sc1
  s_mov_b64 exec, -1
L_h0e_65:
  s_cmp_lg_u32 s38, 0
  s_cbranch_scc1 L_h0e_66
  s_lshl_b32 s61, s37, 7
  s_mov_b32 s60, 0
  s_add_u32 s61, s61, s60
  s_add_u32 s61, s61, 2359300
  s_and_b32 s61, s37, 15
  s_lshl_b32 s61, s61, 7
  s_lshl_b32 s60, s36, 11
  s_add_u32 s61, s61, s60
  s_add_u32 s61, s61, 2113540
  v_mov_b32 v8, 0
  s_branch L_sn2_68
L_sn_67:
  s_sleep 24
L_sn2_68:
  buffer_load_dword v9, v8, s[40:43], s61 offen sc1
  s_waitcnt vmcnt(0)
  v_readfirstlane_b32 s82, v9
  s_add_u32 s80, s80, 1
  s_cmp_gt_u32 s80, 400000
  s_cbranch_scc1 L_abort
  s_cmp_eq_u32 s82, s81
  s_cbranch_scc0 L_sn_67
  s_lshl_b32 s60, s36, 11
  s_add_u32 s60, s60, 2113536
  v_lshlrev_b32 v6, 5, v0
  v_and_b32 v7, 31, v0
  v_lshlrev_b32 v7, 2, v7
  s_lshl_b32 s61, s36, 7
  s_add_u32 s61, s61, 2162688
L_qp_69:
  buffer_load_dwordx4 v[8:11], v6, s[40:43], s60 offen sc1
  buffer_load_dwordx4 v[12:15], v6, s[40:43], s60 offen offset:16 sc1
  buffer_load_dword v17, v7, s[40:43], s61 offen sc1
  s_waitcnt vmcnt(0)
  v_xor_b32 v9, s81, v9
  v_xor_b32 v11, s81, v11
  v_xor_b32 v13, s81, v13
  v_xor_b32 v15, s81, v15
  v_xor_b32 v17, s81, v17
  v_mov_b32 v18, v17
  v_lshrrev_b32 v17, 4, v17
  v_or3_b32 v16, v9, v11, v13
  v_or3_b32 v16, v16, v15, v17
  v_cmp_eq_u32 vcc, 0, v16
  s_add_u32 s80, s80, 1
  s_cmp_gt_u32 s80, 400000
  s_cbranch_scc1 L_abort
  s_cmp_eq_u64 vcc, exec
  s_cbranch_scc1 L_pk_70
  s_sleep 4
  s_branch L_qp_69
L_pk_70:
  v_cmp_eq_u32 vcc, s57, v18
  s_nop 0
  s_cmp_eq_u64 vcc, exec
  s_cselect_b32 s58, 1, 0
  v_mov_b32 v9, v10
  v_mov_b32 v10, v12
  v_mov_b32 v11, v14
  v_lshlrev_b32 v6, 4, v0
  v_add_u32 v6, 147712, v6
  ds_write_b128 v6, v[8:11]
  v_mov_b32 v12, 153064
  v_mov_b32 v13, s58
  s_mov_b64 exec, 1
  ds_write_b32 v12, v13
  s_mov_b64 exec, -1
  s_waitcnt lgkmcnt(0)
L_h0e_66:
  s_barrier
  v_mov_b32 v38, 153064
  ds_read_b32 v39, v38
  s_waitcnt lgkmcnt(0)
  v_readfirstlane_b32 s58, v39
  s_sub_u32 s75, s37, 29
L_fin_common:
  s_cmp_lg_u32 s38, 0
  s_cbranch_scc1 L_h0e_71
  s_lshl_b32 s69, s36, 6
  s_lshl_b32 s61, s75, 4
  s_add_u32 s69, s69, s61
  s_mov_b32 s52, s8
  s_and_b32 s53, s9, 0xffff
  s_mov_b32 s54, 1024
  s_mov_b32 s55, 0x00020000
  v_lshlrev_b32 v6, 1, v1
  s_lshl_b32 s60, s69, 1
  buffer_load_ushort v160, v6, s[52:55], s60 offen
  v_and_b32 v6, 14, v1
  v_lshlrev_b32 v6, 2, v6
  s_lshl_b32 s60, s69, 2
  s_mov_b32 s61, 0
  s_add_u32 s60, s60, s61
  s_add_u32 s60, s60, 2359296
  s_add_u32 s61, s60, 4096
  s_add_u32 s60, s60, 10240
  v_lshrrev_b32 v7, 3, v0
  v_lshlrev_b32 v7, 7, v7
  v_and_b32 v8, 7, v0
  v_min_u32 v9, 6, v8
  v_lshl_add_u32 v15, v9, 2, v7
  v_lshl_add_u32 v7, v8, 2, v7
  s_mov_b32 s62, 2162720
L_gp_72:
  buffer_load_dwordx2 v[8:9], v6, s[40:43], s61 offen sc1
  buffer_load_dwordx2 v[10:11], v6, s[40:43], s60 offen sc1
  buffer_load_dword v13, v7, s[40:43], s62 offen sc1
  buffer_load_dword v14, v15, s[40:43], s62 offen offset:56 sc1
  s_waitcnt vmcnt(0)
  v_xor_b32 v9, s81, v9
  v_xor_b32 v11, s81, v11
  v_xor_b32 v13, s81, v13
  v_xor_b32 v14, s81, v14
  v_lshrrev_b32 v13, 4, v13
  v_lshrrev_b32 v14, 4, v14
  v_or3_b32 v12, v9, v11, v13
  v_or_b32 v12, v12, v14
  v_cmp_eq_u32 vcc, 0, v12
  s_add_u32 s80, s80, 1
  s_cmp_gt_u32 s80, 400000
  s_cbranch_scc1 L_abort
  s_cmp_eq_u64 vcc, exec
  s_cbranch_scc1 L_pk_73
  s_sleep 8
  s_branch L_gp_72
L_pk_73:
  v_lshlrev_b32 v160, 16, v160
  v_and_b32 v12, 1, v0
  v_cmp_eq_u32 vcc, 1, v12
  v_lshlrev_b32 v161, 16, v8
  v_and_b32 v8, 0xffff0000, v8
  v_cndmask_b32 v161, v161, v8, vcc
  v_lshlrev_b32 v162, 16, v10
  v_and_b32 v10, 0xffff0000, v10
  v_cndmask_b32 v162, v162, v10, vcc
L_h0e_71:
  s_barrier
  s_cmp_lg_u32 s38, 0
  s_cbranch_scc1 L_hend
  s_mov_b32 s78, s37
  v_lshlrev_b32 v6, 7, v2
  v_lshl_add_u32 v6, v1, 3, v6
  s_lshl_b32 s64, s36, 5
  s_add_u32 s64, s64, s78
  s_lshl_b32 s64, s64, 12
  s_add_u32 s65, s64, 5242880
  s_lshl_b32 s62, s36, 12
  s_lshl_b32 s61, s78, 7
  s_add_u32 s62, s62, s61
  s_add_u32 s63, s62, 2293760
  s_add_u32 s62, s62, 2228224
  s_cmp_eq_u32 s58, 0
  s_cbranch_scc1 L_asd_75
  v_lshlrev_b32 v28, 7, v0
  v_add_u32 v28, 4, v28
  s_mov_b32 s77, 0
  s_mov_b32 exec_hi, 0
L_as_74:
  buffer_load_dword v29, v28, s[40:43], s65 offen nt
  s_waitcnt vmcnt(0)
  v_cmp_ne_u32 vcc, 0, v29
  s_add_u32 s77, s77, 1
  s_bcnt1_i32_b64 s76, vcc
  s_cmp_ge_u32 s76, 28
  s_cbranch_scc1 L_asd_75
  s_cmp_gt_u32 s77, 400000
  s_cbranch_scc1 L_abort
  s_sleep 10
  s_branch L_as_74
L_asd_75:
  s_mov_b64 exec, -1
  s_cmp_eq_u32 s58, 0
  s_cbranch_scc1 L_tps_79
L_tpf_78:
  buffer_load_dwordx2 v[8:9], v6, s[40:43], s65 offen offset:0 nt
  buffer_load_dwordx2 v[10:11], v6, s[40:43], s65 offen offset:512 nt
  buffer_load_dwordx2 v[12:13], v6, s[40:43], s65 offen offset:1024 nt
  buffer_load_dwordx2 v[14:15], v6, s[40:43], s65 offen offset:1536 nt
  buffer_load_dwordx2 v[16:17], v6, s[40:43], s65 offen offset:2048 nt
  buffer_load_dwordx2 v[18:19], v6, s[40:43], s65 offen offset:2560 nt
  buffer_load_dwordx2 v[20:21], v6, s[40:43], s65 offen offset:3072 nt
  buffer_load_dwordx2 v[22:23], v6, s[40:43], s65 offen offset:3584 nt
  s_waitcnt vmcnt(0)
  v_min3_u32 v24, v8, v9, v10
  v_min3_u32 v24, v24, v11, v12
  v_min3_u32 v24, v24, v13, v14
  v_min3_u32 v24, v24, v15, v16
  v_min3_u32 v24, v24, v17, v18
  v_min3_u32 v24, v24, v19, v20
  v_min3_u32 v24, v24, v21, v22
  v_min_u32 v24, v24, v23
  v_cmp_ne_u32 vcc, 0, v24
  s_add_u32 s80, s80, 1
  s_cmp_gt_u32 s80, 400000
  s_cbranch_scc1 L_abort
  s_cmp_eq_u64 vcc, exec
  s_cbranch_scc0 L_tpf_78
  s_branch L_tpd_77
L_tps_79:
  s_lshl_b32 s76, s36, 3
  s_lshr_b32 s77, s78, 2
  s_add_u32 s76, s76, s77
  s_lshl_b32 s76, s76, 7
  s_add_u32 s76, s76, 2170880
  v_and_b32 v28, 31, v0
  v_lshlrev_b32 v28, 2, v28
L_fa_81:
  buffer_load_dword v29, v28, s[40:43], s76 offen sc1
  s_waitcnt vmcnt(0)
  v_cmp_eq_u32 vcc, s81, v29
  s_add_u32 s80, s80, 1
  s_cmp_gt_u32 s80, 400000
  s_cbranch_scc1 L_abort
  s_cmp_eq_u64 vcc, exec
  s_cbranch_scc0 L_fa_81
L_tps2_80:
  buffer_load_dwordx2 v[8:9], v6, s[40:43], s64 offen offset:0 sc1
  buffer_load_dwordx2 v[10:11], v6, s[40:43], s64 offen offset:512 sc1
  buffer_load_dwordx2 v[12:13], v6, s[40:43], s64 offen offset:1024 sc1
  buffer_load_dwordx2 v[14:15], v6, s[40:43], s64 offen offset:1536 sc1
  buffer_load_dwordx2 v[16:17], v6, s[40:43], s64 offen offset:2048 sc1
  buffer_load_dwordx2 v[18:19], v6, s[40:43], s64 offen offset:2560 sc1
  buffer_load_dwordx2 v[20:21], v6, s[40:43], s64 offen offset:3072 sc1
  buffer_load_dwordx2 v[22:23], v6, s[40:43], s64 offen offset:3584 sc1
  s_waitcnt vmcnt(0)
  v_min3_u32 v24, v8, v9, v10
  v_min3_u32 v24, v24, v11, v12
  v_min3_u32 v24, v24, v13, v14
  v_min3_u32 v24, v24, v15, v16
  v_min3_u32 v24, v24, v17, v18
  v_min3_u32 v24, v24, v19, v20
  v_min3_u32 v24, v24, v21, v22
  v_min_u32 v24, v24, v23
  v_cmp_ne_u32 vcc, 0, v24
  s_add_u32 s80, s80, 1
  s_cmp_gt_u32 s80, 400000
  s_cbranch_scc1 L_abort
  s_cmp_eq_u64 vcc, exec
  s_cbranch_scc0 L_tps2_80
L_tpd_77:
  v_max3_f32 v24, v9, v11, v13
  v_max3_f32 v24, v24, v15, v17
  v_max3_f32 v24, v24, v19, v21
  v_max_f32 v24, v24, v23
  v_mov_b32 v26, v24
  s_nop 1
  v_permlane16_swap_b32 v24, v26
  v_max_f32 v24, v24, v26
  v_mov_b32 v26, v24
  s_nop 1
  v_permlane32_swap_b32 v24, v26
  v_max_f32 v24, v24, v26
  v_sub_f32 v9, v9, v24
  v_sub_f32 v11, v11, v24
  v_sub_f32 v13, v13, v24
  v_sub_f32 v15, v15, v24
  v_sub_f32 v17, v17, v24
  v_sub_f32 v19, v19, v24
  v_sub_f32 v21, v21, v24
  v_sub_f32 v23, v23, v24
  v_exp_f32 v9, v9
  v_exp_f32 v11, v11
  v_exp_f32 v13, v13
  v_exp_f32 v15, v15
  v_exp_f32 v17, v17
  v_exp_f32 v19, v19
  v_exp_f32 v21, v21
  v_exp_f32 v23, v23
  v_mul_f32 v24, v9, v8
  v_mov_b32 v25, v9
  v_fmac_f32 v24, v11, v10
  v_add_f32 v25, v25, v11
  v_fmac_f32 v24, v13, v12
  v_add_f32 v25, v25, v13
  v_fmac_f32 v24, v15, v14
  v_add_f32 v25, v25, v15
  v_fmac_f32 v24, v17, v16
  v_add_f32 v25, v25, v17
  v_fmac_f32 v24, v19, v18
  v_add_f32 v25, v25, v19
  v_fmac_f32 v24, v21, v20
  v_add_f32 v25, v25, v21
  v_fmac_f32 v24, v23, v22
  v_add_f32 v25, v25, v23
  v_mov_b32 v26, v24
  v_mov_b32 v27, v25
  s_nop 0
  v_permlane16_swap_b32 v24, v26
  v_permlane16_swap_b32 v25, v27
  v_add_f32 v24, v24, v26
  v_add_f32 v25, v25, v27
  v_mov_b32 v26, v24
  v_mov_b32 v27, v25
  s_nop 0
  v_permlane32_swap_b32 v24, v26
  v_permlane32_swap_b32 v25, v27
  v_add_f32 v24, v24, v26
  v_add_f32 v25, v25, v27
  v_rcp_f32 v25, v25
  v_lshlrev_b32 v6, 3, v1
  v_mul_f32 v24, v24, v25
  v_mov_b32 v25, s81
  s_mov_b64 exec, 0xffff
  s_cmp_eq_u32 s58, 0
  s_cbranch_scc1 L_tb_82
  buffer_store_dwordx2 v[24:25], v6, s[40:43], s63 offen
  s_branch L_tb2_83
L_tb_82:
  buffer_store_dwordx2 v[24:25], v6, s[40:43], s62 offen sc1
L_tb2_83:
  s_mov_b64 exec, -1
  s_cmp_eq_u32 s58, 0
  s_cbranch_scc1 L_bsd_86
  v_and_b32 v28, 31, v0
  v_lshlrev_b32 v28, 7, v28
  v_add_u32 v28, 4, v28
  s_lshl_b32 s76, s36, 12
  s_add_u32 s76, s76, 2293760
  s_mov_b32 s77, 0
  s_branch L_bs2_85
L_bs_84:
  s_sleep 2
L_bs2_85:
  buffer_load_dword v29, v28, s[40:43], s76 offen nt
  s_waitcnt vmcnt(0)
  v_cmp_eq_u32 vcc, s81, v29
  s_nop 0
  s_cmp_eq_u64 vcc, exec
  s_cbranch_scc1 L_bsd_86
  s_add_u32 s77, s77, 1
  s_cmp_lt_u32 s77, 64
  s_cbranch_scc1 L_bs_84
L_bsd_86:
  v_lshlrev_b32 v6, 2, v1
  s_lshl_b32 s60, s69, 2
  s_and_b32 s61, s36, 1
  s_lshl_b32 s61, s61, 14
  s_add_u32 s60, s60, s61
  s_add_u32 s60, s60, 1310720
  s_add_u32 s61, s60, 4096
  s_add_u32 s62, s60, 8192
  s_add_u32 s63, s60, 12288
L_cp_87:
  buffer_load_dword v8, v6, s[40:43], s60 offen offset:0 sc1
  buffer_load_dword v9, v6, s[40:43], s60 offen offset:2048 sc1
  buffer_load_dword v10, v6, s[40:43], s61 offen offset:0 sc1
  buffer_load_dword v11, v6, s[40:43], s61 offen offset:2048 sc1
  buffer_load_dword v12, v6, s[40:43], s62 offen offset:0 sc1
  buffer_load_dword v13, v6, s[40:43], s62 offen offset:2048 sc1
  buffer_load_dword v14, v6, s[40:43], s63 offen offset:0 sc1
  buffer_load_dword v15, v6, s[40:43], s63 offen offset:2048 sc1
  s_waitcnt vmcnt(0)
  v_min3_u32 v16, v8, v9, v10
  v_min3_u32 v16, v16, v11, v12
  v_min3_u32 v16, v16, v13, v14
  v_min_u32 v16, v16, v15
  v_cmp_ne_u32 vcc, 0, v16
  s_add_u32 s80, s80, 1
  s_cmp_gt_u32 s80, 400000
  s_cbranch_scc1 L_abort
  s_cmp_eq_u64 vcc, exec
  s_cbranch_scc1 L_pk_88
  s_sleep 2
  s_branch L_cp_87
L_pk_88:
  v_add_f32 v8, v8, v9
  v_add_f32 v10, v10, v11
  v_add_f32 v12, v12, v13
  v_add_f32 v14, v14, v15
  v_add_f32 v8, v8, v10
  v_add_f32 v12, v12, v14
  v_add_f32 v8, v8, v12
  v_fmac_f32 v160, v161, v8
  s_mov_b32 s52, s30
  s_and_b32 s53, s31, 0xffff
  s_mov_b32 s54, 1024
  s_mov_b32 s55, 0x00020000
  v_lshlrev_b32 v6, 11, v2
  v_lshl_add_u32 v6, v1, 2, v6
  s_lshl_b32 s76, s69, 1
  s_lshl_b32 s60, s69, 2
  s_add_u32 s60, s60, 1081344
  s_add_u32 s61, s60, 8192
  s_add_u32 s62, s60, 16384
  s_add_u32 s63, s60, 24576
  s_add_u32 s64, s60, 32768
  s_add_u32 s65, s60, 40960
  s_add_u32 s66, s60, 49152
  s_add_u32 s67, s60, 57344
  s_add_u32 s68, s60, 65536
  s_add_u32 s69, s60, 73728
  s_add_u32 s72, s60, 81920
  s_add_u32 s73, s60, 90112
  s_add_u32 s74, s60, 98304
  s_add_u32 s75, s60, 106496
L_ep_89:
  buffer_load_dword v8, v6, s[40:43], s60 offen sc1
  buffer_load_dword v9, v6, s[40:43], s61 offen sc1
  buffer_load_dword v10, v6, s[40:43], s62 offen sc1
  buffer_load_dword v11, v6, s[40:43], s63 offen sc1
  buffer_load_dword v12, v6, s[40:43], s64 offen sc1
  buffer_load_dword v13, v6, s[40:43], s65 offen sc1
  buffer_load_dword v14, v6, s[40:43], s66 offen sc1
  buffer_load_dword v15, v6, s[40:43], s67 offen sc1
  buffer_load_dword v16, v6, s[40:43], s68 offen sc1
  buffer_load_dword v17, v6, s[40:43], s69 offen sc1
  buffer_load_dword v18, v6, s[40:43], s72 offen sc1
  buffer_load_dword v19, v6, s[40:43], s73 offen sc1
  buffer_load_dword v20, v6, s[40:43], s74 offen sc1
  buffer_load_dword v21, v6, s[40:43], s75 offen sc1
  s_waitcnt vmcnt(0)
  v_min3_u32 v24, v8, v9, v10
  v_min3_u32 v24, v24, v11, v12
  v_min3_u32 v24, v24, v13, v14
  v_min3_u32 v24, v24, v15, v16
  v_min3_u32 v24, v24, v17, v18
  v_min3_u32 v24, v24, v19, v20
  v_min_u32 v24, v24, v21
  v_cmp_ne_u32 vcc, 0, v24
  s_add_u32 s80, s80, 1
  s_cmp_gt_u32 s80, 400000
  s_cbranch_scc1 L_abort
  s_cmp_eq_u64 vcc, exec
  s_cbranch_scc0 L_ep_89
  v_add_f32 v8, v8, v9
  v_add_f32 v10, v10, v11
  v_add_f32 v12, v12, v13
  v_add_f32 v14, v14, v15
  v_add_f32 v16, v16, v17
  v_add_f32 v18, v18, v19
  v_add_f32 v20, v20, v21
  v_add_f32 v8, v8, v10
  v_add_f32 v12, v12, v14
  v_add_f32 v16, v16, v18
  v_add_f32 v8, v8, v12
  v_add_f32 v16, v16, v20
  v_add_f32 v148, v8, v16
  v_mov_b32 v150, v148
  s_nop 1
  v_permlane16_swap_b32 v148, v150
  v_add_f32 v148, v148, v150
  v_mov_b32 v150, v148
  s_nop 1
  v_permlane32_swap_b32 v148, v150
  v_add_f32 v148, v148, v150
  v_cvt_pk_bf16_f32 v149, v148, v148
  v_lshlrev_b32 v148, 16, v149
  v_fmac_f32 v160, v162, v148
  v_cvt_pk_bf16_f32 v148, v160, v160
  v_lshlrev_b32 v149, 1, v1
  s_mov_b64 exec, 0xffff
  buffer_store_short v148, v149, s[52:55], s76 offen
  s_lshl_b32 s60, s37, 3
  s_add_u32 s60, s60, s36
  s_cmp_lg_u32 s60, 232
  s_cbranch_scc1 L_hend
  s_add_u32 s83, s83, 1
  v_mov_b32 v151, s83
  v_mov_b32 v150, 0
  s_mov_b32 s60, 3145728
  s_mov_b64 exec, 1
  buffer_store_dword v151, v150, s[40:43], s60 offen
  s_branch L_hend
L_role_ffn:
  s_mov_b32 s48, s20
  s_and_b32 s49, s21, 0xffff
  s_mov_b32 s50, 1835008
  s_mov_b32 s51, 0x00020000
  s_mov_b32 s52, s22
  s_and_b32 s53, s23, 0xffff
  s_mov_b32 s54, 1835008
  s_mov_b32 s55, 0x00020000
  v_lshrrev_b32 v158, 2, v0
  s_mov_b32 s61, 3584
  v_mul_lo_u32 v158, v158, s61
  v_and_b32 v7, 3, v0
  v_lshl_add_u32 v158, v7, 4, v158
  s_mul_i32 s72, s36, 448
  s_sub_u32 s61, s37, 22
  s_lshl_b32 s61, s61, 6
  s_add_u32 s72, s72, s61
  s_lshr_b32 s68, s72, 1
  s_mul_i32 s61, s38, 458752
  s_add_u32 s72, s72, s61
  s_mov_b32 s73, s72
  s_lshl_b32 s66, s38, 13
  s_add_u32 s66, s66, 0
  s_add_u32 s74, s66, 32768
  s_waitcnt lgkmcnt(0)
  s_barrier
  s_cmp_lg_u32 s38, 0
  s_cbranch_scc1 L_h0e_90
  v_mov_b32 v8, 0
  v_mov_b32 v9, 0
  v_mov_b32 v10, 0
  v_mov_b32 v11, 0
  v_lshlrev_b32 v6, 4, v0
  s_lshl_b32 s60, s36, 5
  s_add_u32 s60, s60, s37
  s_lshl_b32 s60, s60, 12
  s_add_u32 s60, s60, 5242880
  buffer_store_dwordx4 v[8:11], v6, s[40:43], s60 offen offset:0
  buffer_store_dwordx4 v[8:11], v6, s[40:43], s60 offen offset:1024
  buffer_store_dwordx4 v[8:11], v6, s[40:43], s60 offen offset:2048
  buffer_store_dwordx4 v[8:11], v6, s[40:43], s60 offen offset:3072
  s_mul_i32 s60, s36, 7
  s_add_u32 s60, s60, s37
  s_sub_u32 s60, s60, 22
  s_lshl_b32 s60, s60, 11
  s_add_u32 s60, s60, 1081344
  buffer_store_dwordx4 v[8:11], v6, s[40:43], s60 offen sc1
  buffer_store_dwordx4 v[8:11], v6, s[40:43], s60 offen offset:1024 sc1
  s_mov_b64 exec, -1
L_h0e_90:
  s_waitcnt lgkmcnt(0)
  s_mul_i32 s81, s83, 0x9E3779B1
  s_add_u32 s81, s81, 0x7F4A7C15
  s_cmp_lg_u32 s38, 0
  s_cbranch_scc1 L_h0e_91
  s_waitcnt vmcnt(0)
  s_lshl_b32 s60, s36, 7
  s_lshl_b32 s61, s37, 2
  s_add_u32 s60, s60, s61
  s_add_u32 s60, s60, 2162688
  s_mov_b64 exec, 1
  s_xor_b32 s61, s81, s57
  v_mov_b32 v38, 0
  v_mov_b32 v39, s61
  buffer_store_dword v39, v38, s[40:43], s60 offen sc1
  s_mov_b64 exec, -1
L_h0e_91:
  s_cmp_eq_u32 s38, 0
  s_cbranch_scc1 L_f1_92
  s_add_u32 m0, s66, 0
  s_nop 0
  buffer_load_dwordx4 v158, s[48:51], s72 offen nt lds
  s_add_u32 s72, s72, 57344
  s_add_u32 m0, s66, 1024
  s_nop 0
  buffer_load_dwordx4 v158, s[48:51], s72 offen nt lds
  s_add_u32 s72, s72, 57344
  s_add_u32 m0, s66, 2048
  s_nop 0
  buffer_load_dwordx4 v158, s[48:51], s72 offen nt lds
  s_add_u32 s72, s72, 57344
  s_waitcnt vmcnt(2)
  s_add_u32 m0, s66, 3072
  s_nop 0
  buffer_load_dwordx4 v158, s[48:51], s72 offen nt lds
  s_add_u32 s72, s72, 57344
  s_waitcnt vmcnt(2)
  s_add_u32 m0, s66, 4096
  s_nop 0
  buffer_load_dwordx4 v158, s[48:51], s72 offen nt lds
  s_add_u32 s72, s72, 57344
  s_waitcnt vmcnt(2)
  s_add_u32 m0, s66, 5120
  s_nop 0
  buffer_load_dwordx4 v158, s[48:51], s72 offen nt lds
  s_add_u32 s72, s72, 57344
  s_waitcnt vmcnt(2)
  s_add_u32 m0, s66, 6144
  s_nop 0
  buffer_load_dwordx4 v158, s[48:51], s72 offen nt lds
  s_add_u32 s72, s72, 57344
  s_waitcnt vmcnt(2)
  s_add_u32 m0, s66, 7168
  s_nop 0
  buffer_load_dwordx4 v158, s[48:51], s72 offen nt lds
  s_waitcnt vmcnt(2)
  s_add_u32 m0, s74, 0
  s_nop 0
  buffer_load_dwordx4 v158, s[52:55], s73 offen nt lds
  s_add_u32 s73, s73, 57344
  s_waitcnt vmcnt(2)
  s_add_u32 m0, s74, 1024
  s_nop 0
  buffer_load_dwordx4 v158, s[52:55], s73 offen nt lds
  s_add_u32 s73, s73, 57344
  s_waitcnt vmcnt(2)
  s_add_u32 m0, s74, 2048
  s_nop 0
  buffer_load_dwordx4 v158, s[52:55], s73 offen nt lds
  s_add_u32 s73, s73, 57344
  s_waitcnt vmcnt(2)
  s_add_u32 m0, s74, 3072
  s_nop 0
  buffer_load_dwordx4 v158, s[52:55], s73 offen nt lds
  s_add_u32 s73, s73, 57344
  s_waitcnt vmcnt(2)
  s_add_u32 m0, s74, 4096
  s_nop 0
  buffer_load_dwordx4 v158, s[52:55], s73 offen nt lds
  s_add_u32 s73, s73, 57344
  s_waitcnt vmcnt(2)
  s_add_u32 m0, s74, 5120
  s_nop 0
  buffer_load_dwordx4 v158, s[52:55], s73 offen nt lds
  s_add_u32 s73, s73, 57344
  s_waitcnt vmcnt(2)
  s_add_u32 m0, s74, 6144
  s_nop 0
  buffer_load_dwordx4 v158, s[52:55], s73 offen nt lds
  s_add_u32 s73, s73, 57344
  s_waitcnt vmcnt(2)
  s_add_u32 m0, s74, 7168
  s_nop 0
  buffer_load_dwordx4 v158, s[52:55], s73 offen nt lds
  s_branch L_f2_93
L_f1_92:
  s_add_u32 m0, s66, 0
  s_nop 0
  buffer_load_dwordx4 v158, s[48:51], s72 offen nt lds
  s_add_u32 s72, s72, 57344
  s_add_u32 m0, s66, 1024
  s_nop 0
  buffer_load_dwordx4 v158, s[48:51], s72 offen nt lds
  s_add_u32 s72, s72, 57344
  s_add_u32 m0, s66, 2048
  s_nop 0
  buffer_load_dwordx4 v158, s[48:51], s72 offen nt lds
  s_add_u32 s72, s72, 57344
  s_add_u32 m0, s66, 3072
  s_nop 0
  buffer_load_dwordx4 v158, s[48:51], s72 offen nt lds
  s_add_u32 s72, s72, 57344
  s_add_u32 m0, s66, 4096
  s_nop 0
  buffer_load_dwordx4 v158, s[48:51], s72 offen nt lds
  s_add_u32 s72, s72, 57344
  s_waitcnt vmcnt(4)
  s_add_u32 m0, s66, 5120
  s_nop 0
  buffer_load_dwordx4 v158, s[48:51], s72 offen nt lds
  s_add_u32 s72, s72, 57344
  s_waitcnt vmcnt(4)
  s_add_u32 m0, s66, 6144
  s_nop 0
  buffer_load_dwordx4 v158, s[48:51], s72 offen nt lds
  s_add_u32 s72, s72, 57344
  s_waitcnt vmcnt(4)
  s_add_u32 m0, s66, 7168
  s_nop 0
  buffer_load_dwordx4 v158, s[48:51], s72 offen nt lds
  s_waitcnt vmcnt(4)
  s_add_u32 m0, s74, 0
  s_nop 0
  buffer_load_dwordx4 v158, s[52:55], s73 offen nt lds
  s_add_u32 s73, s73, 57344
  s_waitcnt vmcnt(4)
  s_add_u32 m0, s74, 1024
  s_nop 0
  buffer_load_dwordx4 v158, s[52:55], s73 offen nt lds
  s_add_u32 s73, s73, 57344
  s_waitcnt vmcnt(4)
  s_add_u32 m0, s74, 2048
  s_nop 0
  buffer_load_dwordx4 v158, s[52:55], s73 offen nt lds
  s_add_u32 s73, s73, 57344
  s_waitcnt vmcnt(4)
  s_add_u32 m0, s74, 3072
  s_nop 0
  buffer_load_dwordx4 v158, s[52:55], s73 offen nt lds
  s_add_u32 s73, s73, 57344
  s_waitcnt vmcnt(4)
  s_add_u32 m0, s74, 4096
  s_nop 0
  buffer_load_dwordx4 v158, s[52:55], s73 offen nt lds
  s_add_u32 s73, s73, 57344
  s_waitcnt vmcnt(4)
  s_add_u32 m0, s74, 5120
  s_nop 0
  buffer_load_dwordx4 v158, s[52:55], s73 offen nt lds
  s_add_u32 s73, s73, 57344
  s_waitcnt vmcnt(4)
  s_add_u32 m0, s74, 6144
  s_nop 0
  buffer_load_dwordx4 v158, s[52:55], s73 offen nt lds
  s_add_u32 s73, s73, 57344
  s_waitcnt vmcnt(4)
  s_add_u32 m0, s74, 7168
  s_nop 0
  buffer_load_dwordx4 v158, s[52:55], s73 offen nt lds
L_f2_93:
  s_cmp_lg_u32 s38, 0
  s_cbranch_scc1 L_h0e_94
  s_lshl_b32 s61, s37, 7
  s_mov_b32 s60, 0
  s_add_u32 s61, s61, s60
  s_add_u32 s61, s61, 2359300
  s_and_b32 s61, s37, 15
  s_lshl_b32 s61, s61, 7
  s_lshl_b32 s60, s36, 11
  s_add_u32 s61, s61, s60
  s_add_u32 s61, s61, 2113540
  v_mov_b32 v8, 0
  s_branch L_sn2_96
L_sn_95:
  s_sleep 24
L_sn2_96:
  buffer_load_dword v9, v8, s[40:43], s61 offen sc1
  s_waitcnt vmcnt(0)
  v_readfirstlane_b32 s82, v9
  s_add_u32 s80, s80, 1
  s_cmp_gt_u32 s80, 400000
  s_cbranch_scc1 L_abort
  s_cmp_eq_u32 s82, s81
  s_cbranch_scc0 L_sn_95
  s_lshl_b32 s60, s36, 11
  s_add_u32 s60, s60, 2113536
  v_lshlrev_b32 v6, 5, v0
  v_and_b32 v7, 31, v0
  v_lshlrev_b32 v7, 2, v7
  s_lshl_b32 s61, s36, 7
  s_add_u32 s61, s61, 2162688
L_qp_97:
  buffer_load_dwordx4 v[8:11], v6, s[40:43], s60 offen sc1
  buffer_load_dwordx4 v[12:15], v6, s[40:43], s60 offen offset:16 sc1
  buffer_load_dword v17, v7, s[40:43], s61 offen sc1
  s_waitcnt vmcnt(0)
  v_xor_b32 v9, s81, v9
  v_xor_b32 v11, s81, v11
  v_xor_b32 v13, s81, v13
  v_xor_b32 v15, s81, v15
  v_xor_b32 v17, s81, v17
  v_mov_b32 v18, v17
  v_lshrrev_b32 v17, 4, v17
  v_or3_b32 v16, v9, v11, v13
  v_or3_b32 v16, v16, v15, v17
  v_cmp_eq_u32 vcc, 0, v16
  s_add_u32 s80, s80, 1
  s_cmp_gt_u32 s80, 400000
  s_cbranch_scc1 L_abort
  s_cmp_eq_u64 vcc, exec
  s_cbranch_scc1 L_pk_98
  s_sleep 4
  s_branch L_qp_97
L_pk_98:
  v_cmp_eq_u32 vcc, s57, v18
  s_nop 0
  s_cmp_eq_u64 vcc, exec
  s_cselect_b32 s58, 1, 0
  v_mov_b32 v9, v10
  v_mov_b32 v10, v12
  v_mov_b32 v11, v14
  v_lshlrev_b32 v6, 4, v0
  v_add_u32 v6, 147712, v6
  ds_write_b128 v6, v[8:11]
  v_mov_b32 v12, 153064
  v_mov_b32 v13, s58
  s_mov_b64 exec, 1
  ds_write_b32 v12, v13
  s_mov_b64 exec, -1
  s_waitcnt lgkmcnt(0)
L_h0e_94:
  s_barrier
  v_mov_b32 v38, 153064
  ds_read_b32 v39, v38
  s_waitcnt lgkmcnt(0)
  v_readfirstlane_b32 s58, v39
  s_waitcnt vmcnt(0)
  v_mov_b32 v38, 152960
  v_mov_b32 v39, 1
  s_mov_b64 exec, 1
  ds_add_u32 v38, v39
  s_mov_b64 exec, -1
L_ls_99:
  ds_read_b32 v39, v38
  s_waitcnt lgkmcnt(0)
  v_readfirstlane_b32 s82, v39
  s_add_u32 s80, s80, 1
  s_cmp_gt_u32 s80, 400000
  s_cbranch_scc1 L_abort
  s_cmp_lt_u32 s82, 4
  s_cbranch_scc1 L_ls_99
  v_lshrrev_b32 v6, 2, v1
  v_lshl_add_u32 v6, v2, 3, v6
  v_lshlrev_b32 v6, 6, v6
  v_and_b32 v7, 1, v0
  v_lshl_add_u32 v6, v7, 3, v6
  v_bfe_u32 v7, v0, 1, 1
  v_lshl_add_u32 v6, v7, 15, v6
  s_lshl_b32 s61, s38, 4
  s_add_u32 s61, s61, 0
  v_add_u32 v6, s61, v6
  ds_read_b64_tr_b16 v[40:41], v6 offset:0
  ds_read_b64_tr_b16 v[42:43], v6 offset:256
  ds_read_b64_tr_b16 v[44:45], v6 offset:2048
  ds_read_b64_tr_b16 v[46:47], v6 offset:2304
  ds_read_b64_tr_b16 v[48:49], v6 offset:4096
  ds_read_b64_tr_b16 v[50:51], v6 offset:4352
  ds_read_b64_tr_b16 v[52:53], v6 offset:6144
  ds_read_b64_tr_b16 v[54:55], v6 offset:6400
  ds_read_b64_tr_b16 v[56:57], v6 offset:8192
  ds_read_b64_tr_b16 v[58:59], v6 offset:8448
  s_waitcnt lgkmcnt(4)
  ds_read_b64_tr_b16 v[60:61], v6 offset:10240
  ds_read_b64_tr_b16 v[62:63], v6 offset:10496
  ds_read_b64_tr_b16 v[64:65], v6 offset:12288
  ds_read_b64_tr_b16 v[66:67], v6 offset:12544
  ds_read_b64_tr_b16 v[68:69], v6 offset:14336
  ds_read_b64_tr_b16 v[70:71], v6 offset:14592
  ds_read_b64_tr_b16 v[72:73], v6 offset:16384
  ds_read_b64_tr_b16 v[74:75], v6 offset:16640
  ds_read_b64_tr_b16 v[76:77], v6 offset:18432
  ds_read_b64_tr_b16 v[78:79], v6 offset:18688
  s_waitcnt lgkmcnt(4)
  ds_read_b64_tr_b16 v[80:81], v6 offset:20480
  ds_read_b64_tr_b16 v[82:83], v6 offset:20736
  ds_read_b64_tr_b16 v[84:85], v6 offset:22528
  ds_read_b64_tr_b16 v[86:87], v6 offset:22784
  ds_read_b64_tr_b16 v[88:89], v6 offset:24576
  ds_read_b64_tr_b16 v[90:91], v6 offset:24832
  ds_read_b64_tr_b16 v[92:93], v6 offset:26624
  ds_read_b64_tr_b16 v[94:95], v6 offset:26880
  ds_read_b64_tr_b16 v[96:97], v6 offset:28672
  ds_read_b64_tr_b16 v[98:99], v6 offset:28928
  s_waitcnt lgkmcnt(4)
  ds_read_b64_tr_b16 v[100:101], v6 offset:30720
  ds_read_b64_tr_b16 v[102:103], v6 offset:30976
  s_waitcnt lgkmcnt(0)
  v_mov_b32 v38, 152960
  v_mov_b32 v39, 1
  s_mov_b64 exec, 1
  ds_add_u32 v38, v39
  s_mov_b64 exec, -1
L_ls_101:
  ds_read_b32 v39, v38
  s_waitcnt lgkmcnt(0)
  v_readfirstlane_b32 s82, v39
  s_add_u32 s80, s80, 1
  s_cmp_gt_u32 s80, 400000
  s_cbranch_scc1 L_abort
  s_cmp_lt_u32 s82, 8
  s_cbranch_scc1 L_ls_101
  s_mov_b32 s48, s24
  s_and_b32 s49, s25, 0xffff
  s_mov_b32 s50, 1835008
  s_mov_b32 s51, 0x00020000
  v_lshlrev_b32 v158, 4, v0
  s_lshl_b32 s61, s38, 3
  s_add_u32 s72, s68, s61
  s_lshl_b32 s72, s72, 10
  s_lshl_b32 s66, s38, 13
  s_add_u32 s66, s66, 0
  s_add_u32 m0, s66, 0
  s_nop 0
  buffer_load_dwordx4 v158, s[48:51], s72 offen nt lds
  s_add_u32 s72, s72, 1024
  s_add_u32 m0, s66, 1024
  s_nop 0
  buffer_load_dwordx4 v158, s[48:51], s72 offen nt lds
  s_add_u32 s72, s72, 1024
  s_add_u32 m0, s66, 2048
  s_nop 0
  buffer_load_dwordx4 v158, s[48:51], s72 offen nt lds
  s_add_u32 s72, s72, 1024
  s_add_u32 m0, s66, 3072
  s_nop 0
  buffer_load_dwordx4 v158, s[48:51], s72 offen nt lds
  s_add_u32 s72, s72, 1024
  s_add_u32 m0, s66, 4096
  s_nop 0
  buffer_load_dwordx4 v158, s[48:51], s72 offen nt lds
  s_add_u32 s72, s72, 1024
  s_add_u32 m0, s66, 5120
  s_nop 0
  buffer_load_dwordx4 v158, s[48:51], s72 offen nt lds
  s_add_u32 s72, s72, 1024
  s_add_u32 m0, s66, 6144
  s_nop 0
  buffer_load_dwordx4 v158, s[48:51], s72 offen nt lds
  s_add_u32 s72, s72, 1024
  s_add_u32 m0, s66, 7168
  s_nop 0
  buffer_load_dwordx4 v158, s[48:51], s72 offen nt lds
  s_waitcnt vmcnt(0)
  v_mov_b32 v38, 152960
  v_mov_b32 v39, 1
  s_mov_b64 exec, 1
  ds_add_u32 v38, v39
  s_mov_b64 exec, -1
L_ls_103:
  ds_read_b32 v39, v38
  s_waitcnt lgkmcnt(0)
  v_readfirstlane_b32 s82, v39
  s_add_u32 s80, s80, 1
  s_cmp_gt_u32 s80, 400000
  s_cbranch_scc1 L_abort
  s_cmp_lt_u32 s82, 12
  s_cbranch_scc1 L_ls_103
  v_lshrrev_b32 v6, 2, v1
  v_lshl_add_u32 v6, v2, 3, v6
  v_lshlrev_b32 v6, 10, v6
  v_and_b32 v7, 3, v0
  v_lshl_add_u32 v6, v7, 3, v6
  s_lshl_b32 s61, s38, 8
  s_add_u32 s61, s61, 0
  v_add_u32 v6, s61, v6
  ds_read_b64_tr_b16 v[104:105], v6 offset:0
  ds_read_b64_tr_b16 v[106:107], v6 offset:4096
  ds_read_b64_tr_b16 v[108:109], v6 offset:32
  ds_read_b64_tr_b16 v[110:111], v6 offset:4128
  ds_read_b64_tr_b16 v[112:113], v6 offset:64
  ds_read_b64_tr_b16 v[114:115], v6 offset:4160
  ds_read_b64_tr_b16 v[116:117], v6 offset:96
  ds_read_b64_tr_b16 v[118:119], v6 offset:4192
  ds_read_b64_tr_b16 v[120:121], v6 offset:128
  ds_read_b64_tr_b16 v[122:123], v6 offset:4224
  s_waitcnt lgkmcnt(4)
  ds_read_b64_tr_b16 v[124:125], v6 offset:160
  ds_read_b64_tr_b16 v[126:127], v6 offset:4256
  ds_read_b64_tr_b16 v[128:129], v6 offset:192
  ds_read_b64_tr_b16 v[130:131], v6 offset:4288
  ds_read_b64_tr_b16 v[132:133], v6 offset:224
  ds_read_b64_tr_b16 v[134:135], v6 offset:4320
  s_waitcnt lgkmcnt(0)
  s_mov_b32 s52, s8
  s_and_b32 s53, s9, 0xffff
  s_mov_b32 s54, 1024
  s_mov_b32 s55, 0x00020000
  v_lshlrev_b32 v7, 2, v0
  s_lshl_b32 s60, s38, 8
  buffer_load_dword v142, v7, s[52:55], s60 offen
  v_lshlrev_b32 v6, 3, v0
  s_lshl_b32 s60, s38, 9
  s_mov_b32 s61, 0
  s_add_u32 s60, s60, s61
  s_add_u32 s60, s60, 2363392
  s_add_u32 s61, s60, 4096
  v_lshrrev_b32 v7, 3, v0
  v_lshlrev_b32 v7, 7, v7
  v_and_b32 v8, 7, v0
  v_lshl_add_u32 v7, v8, 2, v7
  s_mov_b32 s62, 2162720
L_gp2_105:
  buffer_load_dwordx2 v[8:9], v6, s[40:43], s60 offen sc1
  buffer_load_dwordx2 v[10:11], v6, s[40:43], s60 offen offset:2048 sc1
  buffer_load_dwordx2 v[12:13], v6, s[40:43], s61 offen sc1
  buffer_load_dword v14, v7, s[40:43], s62 offen sc1
  s_waitcnt vmcnt(0)
  v_xor_b32 v9, s81, v9
  v_xor_b32 v11, s81, v11
  v_xor_b32 v13, s81, v13
  v_xor_b32 v14, s81, v14
  v_lshrrev_b32 v14, 4, v14
  v_or3_b32 v16, v9, v11, v13
  v_or_b32 v16, v16, v14
  v_cmp_eq_u32 vcc, 0, v16
  s_add_u32 s80, s80, 1
  s_cmp_gt_u32 s80, 400000
  s_cbranch_scc1 L_abort
  s_cmp_eq_u64 vcc, exec
  s_cbranch_scc1 L_pk_106
  s_sleep 8
  s_branch L_gp2_105
L_pk_106:
  v_and_b32 v137, 0xffff0000, v8
  v_lshlrev_b32 v136, 16, v8
  v_and_b32 v139, 0xffff0000, v10
  v_lshlrev_b32 v138, 16, v10
  v_and_b32 v141, 0xffff0000, v12
  v_lshlrev_b32 v140, 16, v12
  v_and_b32 v143, 0xffff0000, v142
  v_lshlrev_b32 v142, 16, v142
  v_add_f32 v140, 1.0, v140
  v_add_f32 v141, 1.0, v141
  v_cvt_pk_bf16_f32 v16, v140, v141
  v_lshlrev_b32 v140, 16, v16
  v_and_b32 v141, 0xffff0000, v16
  v_lshlrev_b32 v144, 3, v0
  s_lshl_b32 s72, s38, 9
  s_and_b32 s61, s36, 1
  s_lshl_b32 s61, s61, 14
  s_add_u32 s72, s72, s61
  s_add_u32 s72, s72, 1310720
  s_add_u32 s73, s72, 4096
  s_add_u32 s74, s72, 8192
  s_add_u32 s75, s72, 12288
  v_lshlrev_b32 v145, 2, v0
  s_lshl_b32 s61, s38, 8
  s_add_u32 s61, s61, 148736
  v_add_u32 v145, s61, v145
  v_lshlrev_b32 v4, 4, v2
  v_add_u32 v4, 148736, v4
  v_mov_b32 v146, 152832
  s_lshl_b32 s61, s38, 3
  v_add_u32 v147, s61, v146
  s_barrier
  s_cmp_lg_u32 s38, 0
  s_cbranch_scc1 L_h0e_107
  s_mov_b32 s78, s37
  v_lshlrev_b32 v6, 7, v2
  v_lshl_add_u32 v6, v1, 3, v6
  s_lshl_b32 s64, s36, 5
  s_add_u32 s64, s64, s78
  s_lshl_b32 s64, s64, 12
  s_add_u32 s65, s64, 5242880
  s_lshl_b32 s62, s36, 12
  s_lshl_b32 s61, s78, 7
  s_add_u32 s62, s62, s61
  s_add_u32 s63, s62, 2293760
  s_add_u32 s62, s62, 2228224
  s_cmp_eq_u32 s58, 0
  s_cbranch_scc1 L_asd_109
  v_lshlrev_b32 v28, 7, v0
  v_add_u32 v28, 4, v28
  s_mov_b32 s77, 0
  s_mov_b32 exec_hi, 0
L_as_108:
  buffer_load_dword v29, v28, s[40:43], s65 offen nt
  s_waitcnt vmcnt(0)
  v_cmp_ne_u32 vcc, 0, v29
  s_add_u32 s77, s77, 1
  s_bcnt1_i32_b64 s76, vcc
  s_cmp_ge_u32 s76, 28
  s_cbranch_scc1 L_asd_109
  s_cmp_gt_u32 s77, 400000
  s_cbranch_scc1 L_abort
  s_sleep 10
  s_branch L_as_108
L_asd_109:
  s_mov_b64 exec, -1
  s_cmp_eq_u32 s58, 0
  s_cbranch_scc1 L_tps_113
L_tpf_112:
  buffer_load_dwordx2 v[8:9], v6, s[40:43], s65 offen offset:0 nt
  buffer_load_dwordx2 v[10:11], v6, s[40:43], s65 offen offset:512 nt
  buffer_load_dwordx2 v[12:13], v6, s[40:43], s65 offen offset:1024 nt
  buffer_load_dwordx2 v[14:15], v6, s[40:43], s65 offen offset:1536 nt
  buffer_load_dwordx2 v[16:17], v6, s[40:43], s65 offen offset:2048 nt
  buffer_load_dwordx2 v[18:19], v6, s[40:43], s65 offen offset:2560 nt
  buffer_load_dwordx2 v[20:21], v6, s[40:43], s65 offen offset:3072 nt
  buffer_load_dwordx2 v[22:23], v6, s[40:43], s65 offen offset:3584 nt
  s_waitcnt vmcnt(0)
  v_min3_u32 v24, v8, v9, v10
  v_min3_u32 v24, v24, v11, v12
  v_min3_u32 v24, v24, v13, v14
  v_min3_u32 v24, v24, v15, v16
  v_min3_u32 v24, v24, v17, v18
  v_min3_u32 v24, v24, v19, v20
  v_min3_u32 v24, v24, v21, v22
  v_min_u32 v24, v24, v23
  v_cmp_ne_u32 vcc, 0, v24
  s_add_u32 s80, s80, 1
  s_cmp_gt_u32 s80, 400000
  s_cbranch_scc1 L_abort
  s_cmp_eq_u64 vcc, exec
  s_cbranch_scc0 L_tpf_112
  s_branch L_tpd_111
L_tps_113:
  s_lshl_b32 s76, s36, 3
  s_lshr_b32 s77, s78, 2
  s_add_u32 s76, s76, s77
  s_lshl_b32 s76, s76, 7
  s_add_u32 s76, s76, 2170880
  v_and_b32 v28, 31, v0
  v_lshlrev_b32 v28, 2, v28
L_fa_115:
  buffer_load_dword v29, v28, s[40:43], s76 offen sc1
  s_waitcnt vmcnt(0)
  v_cmp_eq_u32 vcc, s81, v29
  s_add_u32 s80, s80, 1
  s_cmp_gt_u32 s80, 400000
  s_cbranch_scc1 L_abort
  s_cmp_eq_u64 vcc, exec
  s_cbranch_scc0 L_fa_115
L_tps2_114:
  buffer_load_dwordx2 v[8:9], v6, s[40:43], s64 offen offset:0 sc1
  buffer_load_dwordx2 v[10:11], v6, s[40:43], s64 offen offset:512 sc1
  buffer_load_dwordx2 v[12:13], v6, s[40:43], s64 offen offset:1024 sc1
  buffer_load_dwordx2 v[14:15], v6, s[40:43], s64 offen offset:1536 sc1
  buffer_load_dwordx2 v[16:17], v6, s[40:43], s64 offen offset:2048 sc1
  buffer_load_dwordx2 v[18:19], v6, s[40:43], s64 offen offset:2560 sc1
  buffer_load_dwordx2 v[20:21], v6, s[40:43], s64 offen offset:3072 sc1
  buffer_load_dwordx2 v[22:23], v6, s[40:43], s64 offen offset:3584 sc1
  s_waitcnt vmcnt(0)
  v_min3_u32 v24, v8, v9, v10
  v_min3_u32 v24, v24, v11, v12
  v_min3_u32 v24, v24, v13, v14
  v_min3_u32 v24, v24, v15, v16
  v_min3_u32 v24, v24, v17, v18
  v_min3_u32 v24, v24, v19, v20
  v_min3_u32 v24, v24, v21, v22
  v_min_u32 v24, v24, v23
  v_cmp_ne_u32 vcc, 0, v24
  s_add_u32 s80, s80, 1
  s_cmp_gt_u32 s80, 400000
  s_cbranch_scc1 L_abort
  s_cmp_eq_u64 vcc, exec
  s_cbranch_scc0 L_tps2_114
L_tpd_111:
  v_max3_f32 v24, v9, v11, v13
  v_max3_f32 v24, v24, v15, v17
  v_max3_f32 v24, v24, v19, v21
  v_max_f32 v24, v24, v23
  v_mov_b32 v26, v24
  s_nop 1
  v_permlane16_swap_b32 v24, v26
  v_max_f32 v24, v24, v26
  v_mov_b32 v26, v24
  s_nop 1
  v_permlane32_swap_b32 v24, v26
  v_max_f32 v24, v24, v26
  v_sub_f32 v9, v9, v24
  v_sub_f32 v11, v11, v24
  v_sub_f32 v13, v13, v24
  v_sub_f32 v15, v15, v24
  v_sub_f32 v17, v17, v24
  v_sub_f32 v19, v19, v24
  v_sub_f32 v21, v21, v24
  v_sub_f32 v23, v23, v24
  v_exp_f32 v9, v9
  v_exp_f32 v11, v11
  v_exp_f32 v13, v13
  v_exp_f32 v15, v15
  v_exp_f32 v17, v17
  v_exp_f32 v19, v19
  v_exp_f32 v21, v21
  v_exp_f32 v23, v23
  v_mul_f32 v24, v9, v8
  v_mov_b32 v25, v9
  v_fmac_f32 v24, v11, v10
  v_add_f32 v25, v25, v11
  v_fmac_f32 v24, v13, v12
  v_add_f32 v25, v25, v13
  v_fmac_f32 v24, v15, v14
  v_add_f32 v25, v25, v15
  v_fmac_f32 v24, v17, v16
  v_add_f32 v25, v25, v17
  v_fmac_f32 v24, v19, v18
  v_add_f32 v25, v25, v19
  v_fmac_f32 v24, v21, v20
  v_add_f32 v25, v25, v21
  v_fmac_f32 v24, v23, v22
  v_add_f32 v25, v25, v23
  v_mov_b32 v26, v24
  v_mov_b32 v27, v25
  s_nop 0
  v_permlane16_swap_b32 v24, v26
  v_permlane16_swap_b32 v25, v27
  v_add_f32 v24, v24, v26
  v_add_f32 v25, v25, v27
  v_mov_b32 v26, v24
  v_mov_b32 v27, v25
  s_nop 0
  v_permlane32_swap_b32 v24, v26
  v_permlane32_swap_b32 v25, v27
  v_add_f32 v24, v24, v26
  v_add_f32 v25, v25, v27
  v_rcp_f32 v25, v25
  v_lshlrev_b32 v6, 3, v1
  v_mul_f32 v24, v24, v25
  v_mov_b32 v25, s81
  s_mov_b64 exec, 0xffff
  s_cmp_eq_u32 s58, 0
  s_cbranch_scc1 L_tb_116
  buffer_store_dwordx2 v[24:25], v6, s[40:43], s63 offen
  s_branch L_tb2_117
L_tb_116:
  buffer_store_dwordx2 v[24:25], v6, s[40:43], s62 offen sc1
L_tb2_117:
  s_mov_b64 exec, -1
L_h0e_107:
  s_cmp_eq_u32 s58, 0
  s_cbranch_scc1 L_bsd_120
  v_and_b32 v28, 31, v0
  v_lshlrev_b32 v28, 7, v28
  v_add_u32 v28, 4, v28
  s_lshl_b32 s76, s36, 12
  s_add_u32 s76, s76, 2293760
  s_mov_b32 s77, 0
  s_branch L_bs2_119
L_bs_118:
  s_sleep 2
L_bs2_119:
  buffer_load_dword v29, v28, s[40:43], s76 offen nt
  s_waitcnt vmcnt(0)
  v_cmp_eq_u32 vcc, s81, v29
  s_nop 0
  s_cmp_eq_u64 vcc, exec
  s_cbranch_scc1 L_bsd_120
  s_add_u32 s77, s77, 1
  s_cmp_lt_u32 s77, 64
  s_cbranch_scc1 L_bs_118
L_bsd_120:
L_cp2_121:
  buffer_load_dwordx2 v[8:9], v144, s[40:43], s72 offen offset:0 sc1
  buffer_load_dwordx2 v[10:11], v144, s[40:43], s72 offen offset:2048 sc1
  buffer_load_dwordx2 v[12:13], v144, s[40:43], s73 offen offset:0 sc1
  buffer_load_dwordx2 v[14:15], v144, s[40:43], s73 offen offset:2048 sc1
  buffer_load_dwordx2 v[16:17], v144, s[40:43], s74 offen offset:0 sc1
  buffer_load_dwordx2 v[18:19], v144, s[40:43], s74 offen offset:2048 sc1
  buffer_load_dwordx2 v[20:21], v144, s[40:43], s75 offen offset:0 sc1
  buffer_load_dwordx2 v[22:23], v144, s[40:43], s75 offen offset:2048 sc1
  s_waitcnt vmcnt(0)
  v_min3_u32 v24, v8, v9, v10
  v_min3_u32 v24, v24, v11, v12
  v_min3_u32 v24, v24, v13, v14
  v_min3_u32 v24, v24, v15, v16
  v_min3_u32 v24, v24, v17, v18
  v_min3_u32 v24, v24, v19, v20
  v_min3_u32 v24, v24, v21, v22
  v_min_u32 v24, v24, v23
  v_cmp_ne_u32 vcc, 0, v24
  s_add_u32 s80, s80, 1
  s_cmp_gt_u32 s80, 400000
  s_cbranch_scc1 L_abort
  s_cmp_eq_u64 vcc, exec
  s_cbranch_scc0 L_cp2_121
  v_add_f32 v8, v8, v10
  v_add_f32 v9, v9, v11
  v_add_f32 v12, v12, v14
  v_add_f32 v13, v13, v15
  v_add_f32 v16, v16, v18
  v_add_f32 v17, v17, v19
  v_add_f32 v20, v20, v22
  v_add_f32 v21, v21, v23
  v_add_f32 v8, v8, v12
  v_add_f32 v9, v9, v13
  v_add_f32 v16, v16, v20
  v_add_f32 v17, v17, v21
  v_add_f32 v148, v8, v16
  v_add_f32 v149, v9, v17
  v_fmac_f32 v142, v136, v148
  v_fmac_f32 v143, v137, v149
  v_add_f32 v150, v142, v143
  v_mul_f32 v151, v142, v142
  v_fmac_f32 v151, v143, v143
  v_add_f32_dpp v150, v150, v150 quad_perm:[1,0,3,2] row_mask:0xf bank_mask:0xf
  s_nop 0
  v_add_f32_dpp v151, v151, v151 quad_perm:[1,0,3,2] row_mask:0xf bank_mask:0xf
  v_add_f32_dpp v150, v150, v150 quad_perm:[2,3,0,1] row_mask:0xf bank_mask:0xf
  s_nop 0
  v_add_f32_dpp v151, v151, v151 quad_perm:[2,3,0,1] row_mask:0xf bank_mask:0xf
  v_add_f32_dpp v150, v150, v150 row_half_mirror row_mask:0xf bank_mask:0xf
  s_nop 0
  v_add_f32_dpp v151, v151, v151 row_half_mirror row_mask:0xf bank_mask:0xf
  v_add_f32_dpp v150, v150, v150 row_mirror row_mask:0xf bank_mask:0xf
  s_nop 0
  v_add_f32_dpp v151, v151, v151 row_mirror row_mask:0xf bank_mask:0xf
  v_mov_b32 v152, v150
  v_mov_b32 v153, v151
  s_nop 0
  v_permlane16_swap_b32 v150, v152
  v_permlane16_swap_b32 v151, v153
  v_add_f32 v150, v150, v152
  v_add_f32 v151, v151, v153
  v_mov_b32 v152, v150
  v_mov_b32 v153, v151
  s_nop 0
  v_permlane32_swap_b32 v150, v152
  v_permlane32_swap_b32 v151, v153
  v_add_f32 v150, v150, v152
  v_add_f32 v151, v151, v153
  s_mov_b64 exec, 1
  ds_write_b64 v147, v[150:151]
  s_mov_b64 exec, -1
  s_waitcnt lgkmcnt(0)
  s_barrier
  ds_read_b128 v[152:155], v146
  ds_read_b128 v[156:159], v146 offset:16
  s_waitcnt lgkmcnt(0)
  v_add_f32 v152, v152, v154
  v_add_f32 v153, v153, v155
  v_add_f32 v156, v156, v158
  v_add_f32 v157, v157, v159
  v_add_f32 v152, v152, v156
  v_add_f32 v153, v153, v157
  v_mul_f32 v152, 0x3b000000, v152
  v_mul_f32 v153, 0x3b000000, v153
  v_fma_f32 v153, -v152, v152, v153
  v_add_f32 v153, 0x3727c5ac, v153
  v_rsq_f32 v153, v153
  v_sub_f32 v142, v142, v152
  v_sub_f32 v143, v143, v152
  v_mul_f32 v142, v142, v153
  v_mul_f32 v143, v143, v153
  v_fma_f32 v142, v142, v140, v138
  v_fma_f32 v143, v143, v141, v139
  v_cvt_pk_bf16_f32 v150, v142, v143
  ds_write_b32 v145, v150
  s_waitcnt vmcnt(0) lgkmcnt(0)
  s_barrier
  ds_read_b128 v[8:11], v4 offset:0
  ds_read_b128 v[12:15], v4 offset:64
  ds_read_b128 v[16:19], v4 offset:128
  ds_read_b128 v[20:23], v4 offset:192
  ds_read_b128 v[24:27], v4 offset:256
  ds_read_b128 v[28:31], v4 offset:320
  ds_read_b128 v[32:35], v4 offset:384
  ds_read_b128 v[36:39], v4 offset:448
  s_waitcnt lgkmcnt(7)
  v_mfma_f32_16x16x32_bf16 v[136:139], v[8:11], v[40:43], 0
  ds_read_b128 v[8:11], v4 offset:512
  s_waitcnt lgkmcnt(7)
  v_mfma_f32_16x16x32_bf16 v[140:143], v[12:15], v[44:47], 0
  ds_read_b128 v[12:15], v4 offset:576
  s_waitcnt lgkmcnt(7)
  v_mfma_f32_16x16x32_bf16 v[136:139], v[16:19], v[48:51], v[136:139]
  ds_read_b128 v[16:19], v4 offset:640
  s_waitcnt lgkmcnt(7)
  v_mfma_f32_16x16x32_bf16 v[140:143], v[20:23], v[52:55], v[140:143]
  ds_read_b128 v[20:23], v4 offset:704
  s_waitcnt lgkmcnt(7)
  v_mfma_f32_16x16x32_bf16 v[136:139], v[24:27], v[56:59], v[136:139]
  ds_read_b128 v[24:27], v4 offset:768
  s_waitcnt lgkmcnt(7)
  v_mfma_f32_16x16x32_bf16 v[140:143], v[28:31], v[60:63], v[140:143]
  ds_read_b128 v[28:31], v4 offset:832
  s_waitcnt lgkmcnt(7)
  v_mfma_f32_16x16x32_bf16 v[136:139], v[32:35], v[64:67], v[136:139]
  ds_read_b128 v[32:35], v4 offset:896
  s_waitcnt lgkmcnt(7)
  v_mfma_f32_16x16x32_bf16 v[140:143], v[36:39], v[68:71], v[140:143]
  ds_read_b128 v[36:39], v4 offset:960
  s_waitcnt lgkmcnt(7)
  v_mfma_f32_16x16x32_bf16 v[136:139], v[8:11], v[72:75], v[136:139]
  s_waitcnt lgkmcnt(6)
  v_mfma_f32_16x16x32_bf16 v[140:143], v[12:15], v[76:79], v[140:143]
  s_waitcnt lgkmcnt(5)
  v_mfma_f32_16x16x32_bf16 v[136:139], v[16:19], v[80:83], v[136:139]
  s_waitcnt lgkmcnt(4)
  v_mfma_f32_16x16x32_bf16 v[140:143], v[20:23], v[84:87], v[140:143]
  s_waitcnt lgkmcnt(3)
  v_mfma_f32_16x16x32_bf16 v[136:139], v[24:27], v[88:91], v[136:139]
  s_waitcnt lgkmcnt(2)
  v_mfma_f32_16x16x32_bf16 v[140:143], v[28:31], v[92:95], v[140:143]
  s_waitcnt lgkmcnt(1)
  v_mfma_f32_16x16x32_bf16 v[136:139], v[32:35], v[96:99], v[136:139]
  s_waitcnt lgkmcnt(0)
  v_mfma_f32_16x16x32_bf16 v[140:143], v[36:39], v[100:103], v[140:143]
  s_nop 7
  v_add_f32 v136, v136, v140
  v_cvt_pk_bf16_f32 v137, v136, v136
  v_lshlrev_b32 v136, 16, v137
  s_mov_b32 s61, 0xbfb8aa3b
  v_mul_f32 v8, s61, v136
  v_min_f32 v8, 0x42fc0000, v8
  v_exp_f32 v8, v8
  s_nop 0
  v_add_f32 v8, 1.0, v8
  v_rcp_f32 v9, v8
  s_nop 0
  v_fma_f32 v8, -v8, v9, 1.0
  v_fma_f32 v8, v8, v9, v9
  v_mul_f32 v8, v136, v8
  v_cvt_pk_bf16_f32 v9, v8, v8
  v_lshlrev_b32 v8, 16, v9
  s_nop 0
  v_mov_b32_dpp v9, v136 row_ror:8 row_mask:0xf bank_mask:0xf
  v_mul_f32 v8, v8, v9
  v_cvt_pk_bf16_f32 v8, v8, v8
  v_lshlrev_b32 v6, 1, v1
  s_lshl_b32 s61, s38, 4
  s_add_u32 s61, s61, 152896
  v_add_u32 v6, s61, v6
  s_mov_b64 exec, 0xff
  ds_write_b16 v6, v8
  s_mov_b64 exec, -1
  v_lshlrev_b32 v7, 4, v2
  v_add_u32 v7, 152896, v7
  s_mul_i32 s60, s36, 7
  s_add_u32 s60, s60, s37
  s_sub_u32 s60, s60, 22
  s_lshl_b32 s60, s60, 11
  s_lshl_b32 s61, s38, 9
  s_add_u32 s60, s60, s61
  s_add_u32 s60, s60, 1081344
  s_mov_b32 s62, 0xffff0000
  s_mov_b32 s63, 0xffff0000
  s_mov_b32 s64, 0
  s_mov_b32 s65, -1
  s_waitcnt lgkmcnt(0)
  s_barrier
  ds_read_b128 v[136:139], v7
  s_waitcnt lgkmcnt(0)
  v_mfma_f32_16x16x32_bf16 v[8:11], v[136:139], v[104:107], 0
  v_mfma_f32_16x16x32_bf16 v[12:15], v[136:139], v[108:111], 0
  v_mfma_f32_16x16x32_bf16 v[16:19], v[136:139], v[112:115], 0
  v_mfma_f32_16x16x32_bf16 v[20:23], v[136:139], v[116:119], 0
  v_mfma_f32_16x16x32_bf16 v[24:27], v[136:139], v[120:123], 0
  v_mfma_f32_16x16x32_bf16 v[28:31], v[136:139], v[124:127], 0
  v_mfma_f32_16x16x32_bf16 v[32:35], v[136:139], v[128:131], 0
  v_mfma_f32_16x16x32_bf16 v[36:39], v[136:139], v[132:135], 0
  s_nop 1
  v_cndmask_b32 v140, v8, v12, s[62:63]
  s_nop 0
  v_cndmask_b32 v141, v16, v20, s[62:63]
  v_cndmask_b32 v140, v140, v141, s[64:65]
  v_or_b32 v140, 1, v140
  v_cndmask_b32 v142, v24, v28, s[62:63]
  v_cndmask_b32 v143, v32, v36, s[62:63]
  v_cndmask_b32 v142, v142, v143, s[64:65]
  v_or_b32 v142, 1, v142
  v_lshlrev_b32 v6, 2, v0
  v_mov_b32_dpp v144, v140 quad_perm:[0,0,0,0] row_mask:0xf bank_mask:0xf
  v_mov_b32_dpp v145, v140 quad_perm:[1,1,1,1] row_mask:0xf bank_mask:0xf
  v_mov_b32_dpp v146, v140 quad_perm:[2,2,2,2] row_mask:0xf bank_mask:0xf
  v_mov_b32_dpp v147, v140 quad_perm:[3,3,3,3] row_mask:0xf bank_mask:0xf
  v_mov_b32_dpp v148, v142 quad_perm:[0,0,0,0] row_mask:0xf bank_mask:0xf
  v_mov_b32_dpp v149, v142 quad_perm:[1,1,1,1] row_mask:0xf bank_mask:0xf
  v_mov_b32_dpp v150, v142 quad_perm:[2,2,2,2] row_mask:0xf bank_mask:0xf
  v_mov_b32_dpp v151, v142 quad_perm:[3,3,3,3] row_mask:0xf bank_mask:0xf
  s_mov_b32 exec_lo, 0x11111111
  s_mov_b32 exec_hi, 0x11111111
  buffer_store_dwordx4 v[144:147], v6, s[40:43], s60 offen sc1
  buffer_store_dwordx4 v[148:151], v6, s[40:43], s60 offen offset:256 sc1
  s_branch L_hend
L_tail_plain:
  s_mov_b32 s78, s37
  s_barrier
  s_cmp_lg_u32 s38, 0
  s_cbranch_scc1 L_hend
  v_lshlrev_b32 v6, 7, v2
  v_lshl_add_u32 v6, v1, 3, v6
  s_lshl_b32 s64, s36, 5
  s_add_u32 s64, s64, s78
  s_lshl_b32 s64, s64, 12
  s_add_u32 s65, s64, 5242880
  s_lshl_b32 s62, s36, 12
  s_lshl_b32 s61, s78, 7
  s_add_u32 s62, s62, s61
  s_add_u32 s63, s62, 2293760
  s_add_u32 s62, s62, 2228224
  s_cmp_eq_u32 s58, 0
  s_cbranch_scc1 L_asd_123
  v_lshlrev_b32 v28, 7, v0
  v_add_u32 v28, 4, v28
  s_mov_b32 s77, 0
  s_mov_b32 exec_hi, 0
L_as_122:
  buffer_load_dword v29, v28, s[40:43], s65 offen nt
  s_waitcnt vmcnt(0)
  v_cmp_ne_u32 vcc, 0, v29
  s_add_u32 s77, s77, 1
  s_bcnt1_i32_b64 s76, vcc
  s_cmp_ge_u32 s76, 28
  s_cbranch_scc1 L_asd_123
  s_cmp_gt_u32 s77, 400000
  s_cbranch_scc1 L_abort
  s_sleep 10
  s_branch L_as_122
L_asd_123:
  s_mov_b64 exec, -1
  s_cmp_eq_u32 s58, 0
  s_cbranch_scc1 L_tps_127
L_tpf_126:
  buffer_load_dwordx2 v[8:9], v6, s[40:43], s65 offen offset:0 nt
  buffer_load_dwordx2 v[10:11], v6, s[40:43], s65 offen offset:512 nt
  buffer_load_dwordx2 v[12:13], v6, s[40:43], s65 offen offset:1024 nt
  buffer_load_dwordx2 v[14:15], v6, s[40:43], s65 offen offset:1536 nt
  buffer_load_dwordx2 v[16:17], v6, s[40:43], s65 offen offset:2048 nt
  buffer_load_dwordx2 v[18:19], v6, s[40:43], s65 offen offset:2560 nt
  buffer_load_dwordx2 v[20:21], v6, s[40:43], s65 offen offset:3072 nt
  buffer_load_dwordx2 v[22:23], v6, s[40:43], s65 offen offset:3584 nt
  s_waitcnt vmcnt(0)
  v_min3_u32 v24, v8, v9, v10
  v_min3_u32 v24, v24, v11, v12
  v_min3_u32 v24, v24, v13, v14
  v_min3_u32 v24, v24, v15, v16
  v_min3_u32 v24, v24, v17, v18
  v_min3_u32 v24, v24, v19, v20
  v_min3_u32 v24, v24, v21, v22
  v_min_u32 v24, v24, v23
  v_cmp_ne_u32 vcc, 0, v24
  s_add_u32 s80, s80, 1
  s_cmp_gt_u32 s80, 400000
  s_cbranch_scc1 L_abort
  s_cmp_eq_u64 vcc, exec
  s_cbranch_scc0 L_tpf_126
  s_branch L_tpd_125
L_tps_127:
  s_lshl_b32 s76, s36, 3
  s_lshr_b32 s77, s78, 2
  s_add_u32 s76, s76, s77
  s_lshl_b32 s76, s76, 7
  s_add_u32 s76, s76, 2170880
  v_and_b32 v28, 31, v0
  v_lshlrev_b32 v28, 2, v28
L_fa_129:
  buffer_load_dword v29, v28, s[40:43], s76 offen sc1
  s_waitcnt vmcnt(0)
  v_cmp_eq_u32 vcc, s81, v29
  s_add_u32 s80, s80, 1
  s_cmp_gt_u32 s80, 400000
  s_cbranch_scc1 L_abort
  s_cmp_eq_u64 vcc, exec
  s_cbranch_scc0 L_fa_129
L_tps2_128:
  buffer_load_dwordx2 v[8:9], v6, s[40:43], s64 offen offset:0 sc1
  buffer_load_dwordx2 v[10:11], v6, s[40:43], s64 offen offset:512 sc1
  buffer_load_dwordx2 v[12:13], v6, s[40:43], s64 offen offset:1024 sc1
  buffer_load_dwordx2 v[14:15], v6, s[40:43], s64 offen offset:1536 sc1
  buffer_load_dwordx2 v[16:17], v6, s[40:43], s64 offen offset:2048 sc1
  buffer_load_dwordx2 v[18:19], v6, s[40:43], s64 offen offset:2560 sc1
  buffer_load_dwordx2 v[20:21], v6, s[40:43], s64 offen offset:3072 sc1
  buffer_load_dwordx2 v[22:23], v6, s[40:43], s64 offen offset:3584 sc1
  s_waitcnt vmcnt(0)
  v_min3_u32 v24, v8, v9, v10
  v_min3_u32 v24, v24, v11, v12
  v_min3_u32 v24, v24, v13, v14
  v_min3_u32 v24, v24, v15, v16
  v_min3_u32 v24, v24, v17, v18
  v_min3_u32 v24, v24, v19, v20
  v_min3_u32 v24, v24, v21, v22
  v_min_u32 v24, v24, v23
  v_cmp_ne_u32 vcc, 0, v24
  s_add_u32 s80, s80, 1
  s_cmp_gt_u32 s80, 400000
  s_cbranch_scc1 L_abort
  s_cmp_eq_u64 vcc, exec
  s_cbranch_scc0 L_tps2_128
L_tpd_125:
  v_max3_f32 v24, v9, v11, v13
  v_max3_f32 v24, v24, v15, v17
  v_max3_f32 v24, v24, v19, v21
  v_max_f32 v24, v24, v23
  v_mov_b32 v26, v24
  s_nop 1
  v_permlane16_swap_b32 v24, v26
  v_max_f32 v24, v24, v26
  v_mov_b32 v26, v24
  s_nop 1
  v_permlane32_swap_b32 v24, v26
  v_max_f32 v24, v24, v26
  v_sub_f32 v9, v9, v24
  v_sub_f32 v11, v11, v24
  v_sub_f32 v13, v13, v24
  v_sub_f32 v15, v15, v24
  v_sub_f32 v17, v17, v24
  v_sub_f32 v19, v19, v24
  v_sub_f32 v21, v21, v24
  v_sub_f32 v23, v23, v24
  v_exp_f32 v9, v9
  v_exp_f32 v11, v11
  v_exp_f32 v13, v13
  v_exp_f32 v15, v15
  v_exp_f32 v17, v17
  v_exp_f32 v19, v19
  v_exp_f32 v21, v21
  v_exp_f32 v23, v23
  v_mul_f32 v24, v9, v8
  v_mov_b32 v25, v9
  v_fmac_f32 v24, v11, v10
  v_add_f32 v25, v25, v11
  v_fmac_f32 v24, v13, v12
  v_add_f32 v25, v25, v13
  v_fmac_f32 v24, v15, v14
  v_add_f32 v25, v25, v15
  v_fmac_f32 v24, v17, v16
  v_add_f32 v25, v25, v17
  v_fmac_f32 v24, v19, v18
  v_add_f32 v25, v25, v19
  v_fmac_f32 v24, v21, v20
  v_add_f32 v25, v25, v21
  v_fmac_f32 v24, v23, v22
  v_add_f32 v25, v25, v23
  v_mov_b32 v26, v24
  v_mov_b32 v27, v25
  s_nop 0
  v_permlane16_swap_b32 v24, v26
  v_permlane16_swap_b32 v25, v27
  v_add_f32 v24, v24, v26
  v_add_f32 v25, v25, v27
  v_mov_b32 v26, v24
  v_mov_b32 v27, v25
  s_nop 0
  v_permlane32_swap_b32 v24, v26
  v_permlane32_swap_b32 v25, v27
  v_add_f32 v24, v24, v26
  v_add_f32 v25, v25, v27
  v_rcp_f32 v25, v25
  v_lshlrev_b32 v6, 3, v1
  v_mul_f32 v24, v24, v25
  v_mov_b32 v25, s81
  s_mov_b64 exec, 0xffff
  s_cmp_eq_u32 s58, 0
  s_cbranch_scc1 L_tb_130
  buffer_store_dwordx2 v[24:25], v6, s[40:43], s63 offen
  s_branch L_tb2_131
L_tb_130:
  buffer_store_dwordx2 v[24:25], v6, s[40:43], s62 offen sc1
L_tb2_131:
  s_mov_b64 exec, -1
L_hend:
  s_endpgm
L_abort:
  s_endpgm
L_code_end:
.section .rodata,"a"
.p2align 6
.amdhsa_kernel adaLN_cond__gqa_block_cached__swiglu_ffn__decode_kernel
  .amdhsa_next_free_vgpr 168
  .amdhsa_next_free_sgpr 102
  .amdhsa_accum_offset 168
  .amdhsa_group_segment_fixed_size 0
  .amdhsa_kernarg_size 112
  .amdhsa_user_sgpr_count 2
  .amdhsa_user_sgpr_kernarg_segment_ptr 1
  .amdhsa_system_sgpr_workgroup_id_x 1
  .amdhsa_float_denorm_mode_32 3
.end_amdhsa_kernel
```
